```python
import torch

def _softmax(x, axis=-1):
    return torch.softmax(x, dim=axis)
def _gelu(x):
    return torch.nn.functional.gelu(x, approximate="tanh")
def _silu(x):
    return torch.nn.functional.silu(x)
def _sigmoid(x):
    return torch.sigmoid(x)
def _layernorm(x, axis=-1, eps=1e-5):
    m = x.mean(dim=axis, keepdim=True)
    v = x.var(dim=axis, keepdim=True, unbiased=False)
    return (x - m) / torch.sqrt(v + eps)
def _scatter_add(tgt, idx, src, axis=0):
    return tgt.clone().index_add_(axis, idx, src)
def _segment_sum(src, seg, n):
    out = torch.zeros((n,) + src.shape[1:], dtype=src.dtype)
    return out.index_add_(0, seg, src)
def _pad(x, pw):
    flat = tuple(v for pair in reversed(pw) for v in pair)
    return torch.nn.functional.pad(x, flat)

kernel_name = 'gated_mix__compressed_kv_cla__dense_activation_gelu__decode'

def setup_inputs():

    _w = (lambda a: (lambda t: t.to(torch.bfloat16) if t.is_floating_point() else t)(torch.as_tensor(a)))
    def _A_setup():
        B, H, Sq, Sk, D, M = 2, 32, 1, 4096, 128, 576
        Dc = 4 * D
        return {
            "x": _w((lambda *s: torch.randn(*s, dtype=torch.bfloat16) * 0.05)(B, Sq, M)),
            "c_kv": _w((lambda *s: torch.randn(*s, dtype=torch.bfloat16) * 0.8)(B, Sk, Dc)),
            "w_q": _w((lambda *s: torch.randn(*s, dtype=torch.bfloat16) * 6.4)(M, H, D) * (M ** -0.5)),
            "w_uk": _w((lambda *s: torch.randn(*s, dtype=torch.bfloat16) * 6.4)(Dc, H, D) * (Dc ** -0.5)),
            "w_uv": _w((lambda *s: torch.randn(*s, dtype=torch.bfloat16) * 0.8)(Dc, H, D) * (Dc ** -0.5)),
            "w_o": _w((lambda *s: torch.randn(*s, dtype=torch.bfloat16) * 0.8)(H, D, M) * ((H * D) ** -0.5)),
        }
    _A_in = _A_setup()

    def _B_setup():
        B, S, D, F = 2, 1, 576, 4608
        return {
            "x": _w((lambda *s: torch.randn(*s, dtype=torch.bfloat16) * 0.05)(B, S, D)),
            "w1": _w((lambda *s: torch.randn(*s, dtype=torch.bfloat16) * 3.2)(D, F) * (D ** -0.5)),
            "b1": _w((lambda *s: torch.randn(*s, dtype=torch.bfloat16) * 3.2)(F) * 0.01),
            "w2": _w((lambda *s: torch.randn(*s, dtype=torch.bfloat16) * 0.8)(F, D) * (F ** -0.5)),
            "b2": _w((lambda *s: torch.randn(*s, dtype=torch.bfloat16) * 1.6)(D) * 0.01),
        }
    _B_in = _B_setup()

    return {
        "A_x": _A_in["x"],
        "A_c_kv": _A_in["c_kv"],
        "A_w_q": _A_in["w_q"],
        "A_w_uk": _A_in["w_uk"],
        "A_w_uv": _A_in["w_uv"],
        "A_w_o": _A_in["w_o"],
        "B_x": _B_in["x"],
        "B_w1": _B_in["w1"],
        "B_b1": _B_in["b1"],
        "B_w2": _B_in["w2"],
        "B_b2": _B_in["b2"],
        "gate_w": _w((lambda *s: torch.randn(*s, dtype=torch.bfloat16) * 0.05)(576) * 16.0),
    }

def reference(A_x, A_c_kv, A_w_q, A_w_uk, A_w_uv, A_w_o, B_x, B_w1, B_b1, B_w2, B_b2, gate_w):
    def _A_ref(x, c_kv, w_q, w_uk, w_uv, w_o):
        B, Sq, M = x.shape[0], x.shape[1], x.shape[2]
        Sk = c_kv.shape[1]
        H, D = w_q.shape[1], w_q.shape[2]
        q = torch.einsum("bqm,mhd->bhqd", x, w_q)
        k = torch.einsum("bkc,chd->bhkd", c_kv, w_uk)
        v = torch.einsum("bkc,chd->bhkd", c_kv, w_uv)
        scores = torch.einsum("bhqd,bhkd->bhqk", q, k) * (D ** -0.5)
        off = Sk - Sq
        qi = torch.arange(Sq)[:, None]
        kj = torch.arange(Sk)[None, :]
        cmask = kj <= (qi + off)
        scores = torch.where(cmask[None, None], scores, -1e9)
        p = _softmax(scores, axis=-1)
        ctx = torch.einsum("bhqk,bhkd->bhqd", p, v)
        return torch.einsum("bhqd,hdm->bqm", ctx, w_o)

    def _B_ref(x, w1, b1, w2, b2):
        h = torch.einsum("bsd,df->bsf", x, w1) + b1
        h = _gelu(h)
        return torch.einsum("bsf,fd->bsd", h, w2) + b2

    x = A_x
    g = _sigmoid((x * gate_w).sum(-1, keepdims=True))
    a = _A_ref(x, A_c_kv, A_w_q, A_w_uk, A_w_uv, A_w_o)
    b = _B_ref(x, B_w1, B_b1, B_w2, B_b2)
    return g * a + (1 - g) * b
```

```asm
; @launch grid=(256,1,1) block=(256,1,1) lds=154624
.amdgcn_target "amdgcn-amd-amdhsa--gfx950"
.text
.globl gated_mix__compressed_kv_cla__dense_activation_gelu__decode_kernel
.p2align 8
.type gated_mix__compressed_kv_cla__dense_activation_gelu__decode_kernel,@function
gated_mix__compressed_kv_cla__dense_activation_gelu__decode_kernel:
    s_getpc_b64 s[66:67]
    s_cmp_ge_u32 s2, 256
    s_cbranch_scc1 L_end
    s_load_dwordx2 s[4:5], s[0:1], 112
    s_load_dwordx2 s[8:9], s[0:1], 0
    s_load_dwordx2 s[28:29], s[0:1], 8
    s_load_dwordx2 s[12:13], s[0:1], 16
    s_load_dwordx2 s[16:17], s[0:1], 24
    v_lshrrev_b32 v4, 6, v0
    v_and_b32 v1, 63, v0
    s_and_b32 s42, s2, 7
    v_readfirstlane_b32 s3, v4
    s_bfe_u32 s43, s2, 0x40003
    v_and_b32 v2, 15, v0
    v_bfe_u32 v3, v0, 4, 2
    s_mov_b32 s6, 268435456
    s_mov_b32 s7, 0x00020000
    s_lshl_b32 s42, s42, 2
    s_lshr_b32 s48, 0xb3a29180, s42
    s_and_b32 s42, s48, 3
    s_lshr_b32 s49, s2, 7
    s_lshl_b32 s49, s49, 2
    s_add_u32 s42, s42, s49
    s_bitcmp1_b32 s48, 3
    s_cbranch_scc1 L_B
    s_mov_b32 s14, 4718592
    s_mov_b32 s15, 0x00020000
    s_mov_b32 s10, 2304
    s_mov_b32 s11, 0x00020000
    s_lshr_b32 s45, s43, 2
    s_lshl_b32 s45, s45, 3
    s_add_u32 s45, s45, s42
    s_and_b32 s46, s43, 3
    v_mul_u32_u24 v108, 294912, v3
    v_lshl_add_u32 v108, v2, 4, v108
    s_lshl_b32 s49, s46, 4
    s_add_u32 s49, s49, s3
    s_mul_i32 s49, s49, 9
    s_lshl_b32 s50, s49, 13
    s_lshl_b32 s69, s45, 8
    s_add_u32 s50, s50, s69
    v_bfe_u32 v4, v1, 3, 1
    v_mul_u32_u24 v4, 1152, v4
    v_mad_u32_u24 v4, v3, 64, v4
    v_lshl_add_u32 v4, v3, 3, v4
    s_lshr_b32 s49, s49, 1
    s_lshl_b32 s49, s49, 2
    s_waitcnt lgkmcnt(0)
    buffer_load_dwordx4 v[20:23], v4, s[8:11], s49 offen
    buffer_load_dword v24, v4, s[8:11], s49 offen offset:16
    buffer_load_dwordx4 a[0:3], v108, s[12:15], s50 offen nt
    s_addk_i32 s50, 0x2000
    buffer_load_dwordx4 a[4:7], v108, s[12:15], s50 offen nt
    s_addk_i32 s50, 0x2000
    buffer_load_dwordx4 a[8:11], v108, s[12:15], s50 offen nt
    s_addk_i32 s50, 0x2000
    buffer_load_dwordx4 a[12:15], v108, s[12:15], s50 offen nt
    s_addk_i32 s50, 0x2000
    buffer_load_dwordx4 a[16:19], v108, s[12:15], s50 offen nt
    s_addk_i32 s50, 0x2000
    buffer_load_dwordx4 a[20:23], v108, s[12:15], s50 offen nt
    s_addk_i32 s50, 0x2000
    buffer_load_dwordx4 a[24:27], v108, s[12:15], s50 offen nt
    s_addk_i32 s50, 0x2000
    buffer_load_dwordx4 a[28:31], v108, s[12:15], s50 offen nt
    s_addk_i32 s50, 0x2000
    buffer_load_dwordx4 a[32:35], v108, s[12:15], s50 offen nt
    s_load_dwordx2 s[40:41], s[4:5], 0
    s_mov_b32 s18, 4194304
    s_mov_b32 s19, 0x00020000
    v_bfe_u32 v4, v1, 2, 2
    v_lshlrev_b32 v109, 16, v4
    v_lshl_add_u32 v109, v3, 6, v109
    v_and_b32 v5, 3, v1
    v_lshl_add_u32 v109, v5, 4, v109
    s_lshl_b32 s49, s46, 2
    s_add_u32 s49, s49, s3
    s_lshl_b32 s49, s49, 18
    s_add_u32 s49, s49, s69
    buffer_load_dwordx4 a[36:39], v109, s[16:19], s49 offen nt
    s_addk_i32 s49, 0x2000
    buffer_load_dwordx4 a[44:47], v109, s[16:19], s49 offen nt
    s_addk_i32 s49, 0x2000
    s_lshr_b32 s64, s2, 3
    s_mul_i32 s64, s64, 640
    v_lshl_add_u32 v5, v1, 7, s64
    s_cmp_lg_u32 s3, 3
    s_cbranch_scc1 L_nopfA
    s_mov_b64 exec, 31
    global_load_dword v254, v5, s[66:67]
    s_mov_b64 exec, -1
L_nopfA:
    s_branch L_A_rest
L_B:
    s_min_u32 s64, s43, 14
    s_lshl_b32 s64, s64, 3
    s_load_dwordx2 s[90:91], s[0:1], s64
    s_lshl_b32 s64, s43, 1
    s_lshr_b32 s64, 0xf008896c, s64
    s_and_b32 s64, s64, 3
    s_min_u32 s64, s64, s3
    s_lshl_b32 s64, s64, 21
    s_waitcnt lgkmcnt(0)
    s_load_dword s89, s[90:91], s64
    s_lshr_b32 s64, s2, 3
    s_mul_i32 s64, s64, 640
    v_lshl_add_u32 v5, v1, 7, s64
    s_cmp_lg_u32 s3, 3
    s_cbranch_scc1 L_nopfB
    s_mov_b64 exec, 31
    global_load_dword v63, v5, s[66:67]
    s_mov_b64 exec, -1
L_nopfB:
    s_lshr_b32 s48, s43, 2
    s_lshl_b32 s48, s48, 3
    s_add_u32 s48, s48, s42
    s_lshl_b32 s48, s48, 2
    s_and_b32 s49, s43, 3
    s_add_u32 s48, s48, s49
    s_lshl_b32 s49, s48, 11
    s_add_u32 s49, s49, 1835008
    s_lshl_b32 s48, s48, 10
    s_add_u32 s48, s48, 1703936
    s_cmp_eq_u32 s3, 1
    s_cselect_b32 s48, s48, s49
    s_lshl_b32 s49, s42, 4
    s_add_u32 s49, s49, s43
    s_lshl_b32 s49, s49, 10
    s_add_u32 s49, s49, 65536
    s_cmp_eq_u32 s3, 2
    s_cselect_b32 s48, s49, s48
    s_cselect_b32 s64, 0xff, -1
    s_and_b32 s64, s64, 0xffff
    s_mov_b32 s65, 0
    v_lshlrev_b32 v4, 7, v1
    s_load_dwordx2 s[40:41], s[4:5], 0
    s_cmp_lg_u32 s3, 2
    s_cbranch_scc1 L_B_head
    s_mov_b64 exec, s[64:65]
    buffer_load_dword v62, v4, s[4:7], s48 offen
    s_mov_b64 exec, -1
L_B_head:
    s_mov_b32 s30, 8388608
    s_mov_b32 s31, 0x00020000
    s_and_b32 s45, s42, 1
    s_lshr_b32 s46, s43, 1
    s_lshl_b32 s46, s46, 2
    s_lshr_b32 s48, s42, 1
    s_add_u32 s46, s46, s48
    s_lshl_b32 s48, s45, 5
    s_add_u32 s46, s46, s48
    v_lshlrev_b32 v12, 4, v1
    s_lshl_b32 s37, s46, 2
    s_add_u32 s37, s37, s3
    s_lshl_b32 s37, s37, 15
    s_lshl_b32 m0, s3, 15
    s_add_u32 m0, m0, 23552
    v_xor_b32 v4, 0, v12
    buffer_load_dwordx4 v4, s[28:31], s37 offen offset:0  lds
    v_xor_b32 v5, 32, v12
    buffer_load_dwordx4 v5, s[28:31], s37 offen offset:1024  lds
    v_xor_b32 v4, 64, v12
    buffer_load_dwordx4 v4, s[28:31], s37 offen offset:2048  lds
    v_xor_b32 v5, 96, v12
    buffer_load_dwordx4 v5, s[28:31], s37 offen offset:3072  lds
    s_addk_i32 s37, 4096
    s_add_u32 m0, m0, 0x1000
    v_xor_b32 v4, 128, v12
    buffer_load_dwordx4 v4, s[28:31], s37 offen offset:0  lds
    v_xor_b32 v5, 160, v12
    buffer_load_dwordx4 v5, s[28:31], s37 offen offset:1024  lds
    v_xor_b32 v4, 192, v12
    buffer_load_dwordx4 v4, s[28:31], s37 offen offset:2048  lds
    v_xor_b32 v5, 224, v12
    buffer_load_dwordx4 v5, s[28:31], s37 offen offset:3072  lds
    s_addk_i32 s37, 4096
    s_add_u32 m0, m0, 0x1000
    v_xor_b32 v4, 144, v12
    buffer_load_dwordx4 v4, s[28:31], s37 offen offset:0  lds
    v_xor_b32 v5, 176, v12
    buffer_load_dwordx4 v5, s[28:31], s37 offen offset:1024  lds
    v_xor_b32 v4, 208, v12
    buffer_load_dwordx4 v4, s[28:31], s37 offen offset:2048  lds
    v_xor_b32 v5, 240, v12
    buffer_load_dwordx4 v5, s[28:31], s37 offen offset:3072  lds
    s_addk_i32 s37, 4096
    s_add_u32 m0, m0, 0x1000
    v_xor_b32 v4, 16, v12
    buffer_load_dwordx4 v4, s[28:31], s37 offen offset:0  lds
    v_xor_b32 v5, 48, v12
    buffer_load_dwordx4 v5, s[28:31], s37 offen offset:1024  lds
    v_xor_b32 v4, 80, v12
    buffer_load_dwordx4 v4, s[28:31], s37 offen offset:2048  lds
    v_xor_b32 v5, 112, v12
    buffer_load_dwordx4 v5, s[28:31], s37 offen offset:3072  lds
    s_addk_i32 s37, 4096
    s_add_u32 m0, m0, 0x1000
    s_branch L_B_rest
L_A_rest:
    v_and_b32 v4, 1, v1
    v_cmp_eq_u32 vcc, 1, v4
    v_mov_b32 v5, 0x0c0c0100
    v_mov_b32 v6, 0x01000c0c
    v_cndmask_b32 v15, v5, v6, vcc
    v_mov_b32 v5, 0x0c0c0302
    v_mov_b32 v6, 0x03020c0c
    v_cndmask_b32 v19, v5, v6, vcc
    v_bfe_u32 v4, v1, 1, 2
    v_mov_b32 v5, 0x0c0c0c0c
    v_cmp_eq_u32 vcc, 0, v4
    s_nop 1
    v_cndmask_b32 v12, v5, v15, vcc
    v_cndmask_b32 v16, v5, v19, vcc
    v_cmp_eq_u32 vcc, 1, v4
    s_nop 1
    v_cndmask_b32 v13, v5, v15, vcc
    v_cndmask_b32 v17, v5, v19, vcc
    v_cmp_eq_u32 vcc, 2, v4
    s_nop 1
    v_cndmask_b32 v14, v5, v15, vcc
    v_cndmask_b32 v18, v5, v19, vcc
    v_cmp_eq_u32 vcc, 3, v4
    s_nop 1
    v_cndmask_b32 v15, v5, v15, vcc
    v_cndmask_b32 v19, v5, v19, vcc
    s_lshl_b32 s44, s45, 2
    s_add_u32 s44, s44, s46
    s_and_b32 s48, s3, 1
    s_lshl_b32 s48, s48, 4
    v_lshlrev_b32 v47, 4, v1
    s_cmp_lg_u32 s3, 1
    s_cbranch_scc1 L_A_e2
    v_mov_b32 v8, 0xffa5ffa5
    v_mov_b32 v9, 0xffa5ffa5
    v_mov_b32 v10, 0xffa5ffa5
    v_mov_b32 v11, 0xffa5ffa5
    v_lshlrev_b32 v4, 15, v3
    v_lshl_add_u32 v4, v2, 4, v4
    s_lshl_b32 s64, s44, 8
    s_add_u32 s64, s64, 524288
    s_mov_b32 exec_hi, 0
    buffer_store_dwordx4 v[8:11], v4, s[4:7], s64 offen sc1
    s_mov_b64 exec, -1
L_A_e2:
    s_cmp_lt_u32 s3, 2
    s_cbranch_scc1 L_A_e3
    s_lshl_b32 s64, s44, 11
    s_add_u32 s64, s64, 1835008
    s_lshl_b32 s65, s44, 10
    s_add_u32 s65, s65, 1703936
    s_cmp_eq_u32 s3, 2
    s_cselect_b32 s64, s64, s65
    v_lshlrev_b32 v4, 7, v1
    s_mov_b64 exec, 0xffff
    buffer_load_dword v255, v4, s[4:7], s64 offen
    s_mov_b64 exec, -1
L_A_e3:
    s_waitcnt vmcnt(11)
    v_alignbit_b32 v20, v21, v20, s48
    v_alignbit_b32 v21, v22, v21, s48
    v_alignbit_b32 v22, v23, v22, s48
    v_alignbit_b32 v23, v24, v23, s48
    v_alignbit_b32 v24, v25, v24, s48
    v_perm_b32 v160, v20, v20, v12
    v_perm_b32 v161, v20, v20, v13
    v_perm_b32 v162, v20, v20, v14
    v_perm_b32 v163, v20, v20, v15
    v_perm_b32 v164, v20, v20, v16
    v_perm_b32 v165, v20, v20, v17
    v_perm_b32 v166, v20, v20, v18
    v_perm_b32 v167, v20, v20, v19
    v_perm_b32 v168, v21, v21, v12
    v_perm_b32 v169, v21, v21, v13
    v_perm_b32 v170, v21, v21, v14
    v_perm_b32 v171, v21, v21, v15
    v_perm_b32 v172, v21, v21, v16
    v_perm_b32 v173, v21, v21, v17
    v_perm_b32 v174, v21, v21, v18
    v_perm_b32 v175, v21, v21, v19
    v_perm_b32 v176, v22, v22, v12
    v_perm_b32 v177, v22, v22, v13
    v_perm_b32 v178, v22, v22, v14
    v_perm_b32 v179, v22, v22, v15
    v_perm_b32 v180, v22, v22, v16
    v_perm_b32 v181, v22, v22, v17
    v_perm_b32 v182, v22, v22, v18
    v_perm_b32 v183, v22, v22, v19
    v_perm_b32 v184, v23, v23, v12
    v_perm_b32 v185, v23, v23, v13
    v_perm_b32 v186, v23, v23, v14
    v_perm_b32 v187, v23, v23, v15
    v_perm_b32 v188, v23, v23, v16
    v_perm_b32 v189, v23, v23, v17
    v_perm_b32 v190, v23, v23, v18
    v_perm_b32 v191, v23, v23, v19
    v_perm_b32 v192, v24, v24, v12
    v_perm_b32 v193, v24, v24, v13
    v_perm_b32 v194, v24, v24, v14
    v_perm_b32 v195, v24, v24, v15
    buffer_load_dwordx4 a[52:55], v109, s[16:19], s49 offen nt
    s_addk_i32 s49, 0x2000
    buffer_load_dwordx4 a[60:63], v109, s[16:19], s49 offen nt
    s_addk_i32 s49, 0x2000
    buffer_load_dwordx4 a[40:43], v109, s[16:19], s49 offen nt
    s_addk_i32 s49, 0x2000
    buffer_load_dwordx4 a[48:51], v109, s[16:19], s49 offen nt
    s_addk_i32 s49, 0x2000
    buffer_load_dwordx4 a[56:59], v109, s[16:19], s49 offen nt
    s_addk_i32 s49, 0x2000
    buffer_load_dwordx4 a[64:67], v109, s[16:19], s49 offen nt
    s_addk_i32 s49, 0x2000
    s_waitcnt vmcnt(16)
    v_mfma_f32_16x16x32_bf16 v[202:205], v[160:163], a[0:3], 0
    s_waitcnt vmcnt(15)
    v_mfma_f32_16x16x32_bf16 v[202:205], v[164:167], a[4:7], v[202:205]
    s_waitcnt vmcnt(14)
    v_mfma_f32_16x16x32_bf16 v[202:205], v[168:171], a[8:11], v[202:205]
    s_waitcnt vmcnt(13)
    v_mfma_f32_16x16x32_bf16 v[202:205], v[172:175], a[12:15], v[202:205]
    s_waitcnt vmcnt(12)
    v_mfma_f32_16x16x32_bf16 v[202:205], v[176:179], a[16:19], v[202:205]
    s_waitcnt vmcnt(11)
    v_mfma_f32_16x16x32_bf16 v[202:205], v[180:183], a[20:23], v[202:205]
    s_waitcnt vmcnt(10)
    v_mfma_f32_16x16x32_bf16 v[202:205], v[184:187], a[24:27], v[202:205]
    s_waitcnt vmcnt(9)
    v_mfma_f32_16x16x32_bf16 v[202:205], v[188:191], a[28:31], v[202:205]
    s_waitcnt vmcnt(8)
    v_mfma_f32_16x16x32_bf16 v[202:205], v[192:195], a[32:35], v[202:205]
    s_cmp_eq_u32 s3, 0
    s_cbranch_scc1 L_A_w0a
    v_lshl_add_u32 v4, s3, 10, v47
    s_nop 4
    ds_write_b128 v4, v[202:205] offset:34816
    s_cmp_lg_u32 s3, 1
    s_cbranch_scc1 L_A_nw1
    s_waitcnt vmcnt(6)
L_A_nw1:
    s_waitcnt lgkmcnt(0)
    s_barrier
    s_add_u32 s40, s40, 2654435769
    s_add_u32 s41, s41, 2135587861
    s_branch L_A_setup
L_A_w0a:
    s_waitcnt lgkmcnt(0)
    s_add_u32 s40, s40, 2654435769
    s_add_u32 s41, s41, 2135587861
    s_getreg_b32 s95, hwreg(HW_REG_XCC_ID, 0, 4)
    s_mov_b32 s96, s40
    s_xor_b32 s97, s41, s95
    s_xor_b32 s64, s44, 1
    s_lshl_b32 s64, s64, 11
    s_add_u32 s48, s64, 1835008
    s_xor_b32 s64, s44, 2
    s_lshl_b32 s64, s64, 11
    s_add_u32 s50, s64, 1835008
    s_xor_b32 s64, s44, 3
    s_lshl_b32 s64, s64, 11
    s_add_u32 s69, s64, 1835008
    v_mov_b32 v200, s40
    v_mov_b32 v201, s97
    v_mov_b32 v206, s40
    v_mov_b32 v207, s97
    s_lshl_b32 s65, s44, 11
    s_add_u32 s65, s65, 1835008
    s_barrier
    ds_read_b128 v[56:59], v47 offset:35840
    ds_read_b128 v[60:63], v47 offset:36864
    ds_read_b128 v[64:67], v47 offset:37888
    s_waitcnt lgkmcnt(1)
    v_pk_add_f32 v[202:203], v[202:203], v[56:57]
    v_pk_add_f32 v[204:205], v[204:205], v[58:59]
    s_waitcnt lgkmcnt(0)
    v_pk_add_f32 v[60:61], v[60:61], v[64:65]
    v_pk_add_f32 v[62:63], v[62:63], v[66:67]
    v_pk_add_f32 v[202:203], v[202:203], v[60:61]
    v_pk_add_f32 v[204:205], v[204:205], v[62:63]
    buffer_store_dwordx4 v[200:203], v47, s[4:7], s65 offen
    buffer_store_dwordx4 v[204:207], v47, s[4:7], s65 offen offset:1024
L_A_setup:
    s_load_dwordx2 s[20:21], s[0:1], 32
    s_mov_b32 s22, 4194304
    s_mov_b32 s23, 0x00020000
    s_load_dwordx2 s[24:25], s[0:1], 40
    s_mov_b32 s26, 4718592
    s_mov_b32 s27, 0x00020000
    s_load_dwordx2 s[32:33], s[0:1], 88
    s_mov_b32 s34, 1152
    s_mov_b32 s35, 0x00020000
    s_load_dwordx2 s[36:37], s[0:1], 96
    s_mov_b32 s38, 2304
    s_mov_b32 s39, 0x00020000
    s_load_dwordx2 s[12:13], s[0:1], 56
    s_mov_b32 s14, 5308416
    s_mov_b32 s15, 0x00020000
    v_bfe_u32 v4, v1, 2, 2
    v_lshlrev_b32 v110, 15, v3
    v_lshl_add_u32 v110, v4, 4, v110
    s_lshl_b32 s63, s44, 2
    s_add_u32 s63, s63, s3
    s_lshl_b32 s63, s63, 6
    s_add_u32 s63, s63, 524288
    v_bfe_u32 v4, v1, 2, 1
    v_lshlrev_b32 v4, 8, v4
    v_lshl_add_u32 v4, v3, 6, v4
    v_and_b32 v5, 3, v1
    v_lshl_add_u32 v4, v5, 4, v4
    v_add_u32 v4, 32768, v4
    v_mov_b32 v5, 33280
    v_cmp_gt_u32 vcc, 8, v2
    s_nop 1
    v_cndmask_b32 v112, v5, v4, vcc
    v_cndmask_b32 v113, v4, v5, vcc
    v_and_b32 v4, 1, v1
    v_cmp_eq_u32 s[52:53], 1, v4
    v_and_b32 v4, 2, v1
    v_cmp_eq_u32 s[54:55], 2, v4
    v_mov_b32 v114, s40
    v_mov_b32 v115, s41
    v_lshlrev_b32 v111, 12, v1
    s_lshl_b32 s49, s45, 5
    s_add_u32 s49, s49, s46
    s_lshl_b32 s49, s49, 2
    s_add_u32 s49, s49, 32768
    v_mov_b32 v6, 0
    v_mov_b32 v7, 0
    ds_write_b64 v5, v[6:7]
    ds_write_b64 v5, v[6:7] offset:8
    v_lshrrev_b32 v46, 1, v3
    v_lshlrev_b32 v46, 8, v46
    v_lshl_add_u32 v46, v2, 4, v46
    v_and_b32 v5, 1, v3
    v_lshl_add_u32 v46, v5, 3, v46
    s_cmp_lg_u32 s3, 0
    s_cbranch_scc1 L_A_s2
    buffer_load_dwordx4 v[56:59], v47, s[4:7], s48 offen sc1
    buffer_load_dwordx4 v[60:63], v47, s[4:7], s48 offen offset:1024 sc1
    buffer_load_dwordx4 v[64:67], v47, s[4:7], s50 offen sc1
    buffer_load_dwordx4 v[68:71], v47, s[4:7], s50 offen offset:1024 sc1
    buffer_load_dwordx4 v[72:75], v47, s[4:7], s69 offen sc1
    buffer_load_dwordx4 v[76:79], v47, s[4:7], s69 offen offset:1024 sc1
L_A_s2:
    v_lshlrev_b32 v4, 1, v3
    v_xor_b32 v4, v4, v2
    v_lshlrev_b32 v20, 17, v3
    v_lshl_add_u32 v20, v4, 4, v20
    v_xor_b32 v21, 128, v20
    v_add_u32 v4, 0, v1
    v_mul_u32_u24 v5, 911, v4
    v_lshrrev_b32 v5, 16, v5
    v_and_b32 v22, 6, v5
    v_xor_b32 v22, v22, v4
    v_lshlrev_b32 v22, 4, v22
    v_add_u32 v4, 64, v1
    v_mul_u32_u24 v5, 911, v4
    v_lshrrev_b32 v5, 16, v5
    v_and_b32 v23, 6, v5
    v_xor_b32 v23, v23, v4
    v_lshlrev_b32 v23, 4, v23
    v_add_u32 v4, 128, v1
    v_mul_u32_u24 v5, 911, v4
    v_lshrrev_b32 v5, 16, v5
    v_and_b32 v24, 6, v5
    v_xor_b32 v24, v24, v4
    v_lshlrev_b32 v24, 4, v24
    v_add_u32 v4, 192, v1
    v_mul_u32_u24 v5, 911, v4
    v_lshrrev_b32 v5, 16, v5
    v_and_b32 v25, 6, v5
    v_xor_b32 v25, v25, v4
    v_lshlrev_b32 v25, 4, v25
    v_add_u32 v4, 256, v1
    v_mul_u32_u24 v5, 911, v4
    v_lshrrev_b32 v5, 16, v5
    v_and_b32 v26, 6, v5
    v_xor_b32 v26, v26, v4
    v_lshlrev_b32 v26, 4, v26
    v_add_u32 v4, 320, v1
    v_mul_u32_u24 v5, 911, v4
    v_lshrrev_b32 v5, 16, v5
    v_and_b32 v27, 6, v5
    v_xor_b32 v27, v27, v4
    v_lshlrev_b32 v27, 4, v27
    v_add_u32 v4, 384, v1
    v_mul_u32_u24 v5, 911, v4
    v_lshrrev_b32 v5, 16, v5
    v_and_b32 v28, 6, v5
    v_xor_b32 v28, v28, v4
    v_lshlrev_b32 v28, 4, v28
    v_add_u32 v4, 448, v1
    v_mul_u32_u24 v5, 911, v4
    v_lshrrev_b32 v5, 16, v5
    v_and_b32 v29, 6, v5
    v_xor_b32 v29, v29, v4
    v_lshlrev_b32 v29, 4, v29
    v_add_u32 v4, 512, v1
    v_mul_u32_u24 v5, 911, v4
    v_lshrrev_b32 v5, 16, v5
    v_and_b32 v30, 6, v5
    v_xor_b32 v30, v30, v4
    v_lshlrev_b32 v30, 4, v30
    s_mov_b32 s51, 0
    s_cmp_lg_u32 s3, 0
    s_cbranch_scc1 L_A_h0wait
    s_waitcnt vmcnt(0)
L_A_h0chk:
    v_cmp_ne_u64 vcc, s[96:97], v[56:57]
    v_cmp_ne_u64 s[56:57], s[96:97], v[62:63]
    s_nop 0
    s_or_b64 s[58:59], vcc, s[56:57]
    v_cmp_ne_u64 vcc, s[96:97], v[64:65]
    v_cmp_ne_u64 s[56:57], s[96:97], v[70:71]
    s_or_b64 s[58:59], s[58:59], vcc
    s_or_b64 s[58:59], s[58:59], s[56:57]
    v_cmp_ne_u64 vcc, s[96:97], v[72:73]
    v_cmp_ne_u64 s[56:57], s[96:97], v[78:79]
    s_or_b64 s[58:59], s[58:59], vcc
    s_or_b64 s[58:59], s[58:59], s[56:57]
    s_cbranch_scc1 L_A_h0poll
L_A_h0done:
    s_mov_b64 exec, 0xff
    buffer_store_dword v114, v111, s[4:7], s49 offen sc1
    s_mov_b64 exec, -1
    v_pk_add_f32 v[58:59], v[202:203], v[58:59]
    v_pk_add_f32 v[60:61], v[204:205], v[60:61]
    v_pk_add_f32 v[66:67], v[66:67], v[74:75]
    v_pk_add_f32 v[68:69], v[68:69], v[76:77]
    v_pk_add_f32 v[58:59], v[58:59], v[66:67]
    v_pk_add_f32 v[60:61], v[60:61], v[68:69]
    v_cvt_pk_bf16_f32 v56, v58, v59
    v_cvt_pk_bf16_f32 v57, v60, v61
    ds_write_b64 v46, v[56:57] offset:32768
    s_waitcnt lgkmcnt(0)
    s_barrier
    ds_read_b128 v[80:83], v112
    ds_read_b128 v[84:87], v113
    s_branch L_A_p1b
L_A_h0wait:
    s_waitcnt vmcnt(0) lgkmcnt(0)
    s_barrier
    ds_read_b128 v[80:83], v112
    ds_read_b128 v[84:87], v113
L_A_p1b:
    s_waitcnt lgkmcnt(0)
    v_mfma_f32_16x16x32_bf16 v[88:91], v[80:83], a[36:39], 0
    v_mfma_f32_16x16x32_bf16 v[92:95], v[80:83], a[44:47], 0
    v_mfma_f32_16x16x32_bf16 v[96:99], v[80:83], a[52:55], 0
    v_mfma_f32_16x16x32_bf16 v[100:103], v[80:83], a[60:63], 0
    v_mfma_f32_16x16x32_bf16 v[88:91], v[84:87], a[40:43], v[88:91]
    v_mfma_f32_16x16x32_bf16 v[92:95], v[84:87], a[48:51], v[92:95]
    v_mfma_f32_16x16x32_bf16 v[96:99], v[84:87], a[56:59], v[96:99]
    v_mfma_f32_16x16x32_bf16 v[100:103], v[84:87], a[64:67], v[100:103]
    s_nop 4
    v_cndmask_b32 v88, v88, v89, s[52:53]
    v_cndmask_b32 v90, v90, v91, s[52:53]
    v_cndmask_b32 v88, v88, v90, s[54:55]
    v_cndmask_b32 v92, v92, v93, s[52:53]
    v_cndmask_b32 v94, v94, v95, s[52:53]
    v_cndmask_b32 v92, v92, v94, s[54:55]
    v_cndmask_b32 v96, v96, v97, s[52:53]
    v_cndmask_b32 v98, v98, v99, s[52:53]
    v_cndmask_b32 v96, v96, v98, s[54:55]
    v_cndmask_b32 v100, v100, v101, s[52:53]
    v_cndmask_b32 v102, v102, v103, s[52:53]
    v_cndmask_b32 v100, v100, v102, s[54:55]
    v_add_f32_dpp v89, v88, v88 quad_perm:[1,0,3,2] row_mask:0xf bank_mask:0xf
    v_add_f32_dpp v93, v92, v92 quad_perm:[1,0,3,2] row_mask:0xf bank_mask:0xf
    v_add_f32_dpp v97, v96, v96 quad_perm:[1,0,3,2] row_mask:0xf bank_mask:0xf
    v_add_f32_dpp v101, v100, v100 quad_perm:[1,0,3,2] row_mask:0xf bank_mask:0xf
    v_add_f32_dpp v88, v89, v89 quad_perm:[2,3,0,1] row_mask:0xf bank_mask:0xf
    v_add_f32_dpp v92, v93, v93 quad_perm:[2,3,0,1] row_mask:0xf bank_mask:0xf
    v_add_f32_dpp v96, v97, v97 quad_perm:[2,3,0,1] row_mask:0xf bank_mask:0xf
    v_add_f32_dpp v100, v101, v101 quad_perm:[2,3,0,1] row_mask:0xf bank_mask:0xf
    v_cvt_pk_bf16_f32 v104, v88, v92
    v_cvt_pk_bf16_f32 v105, v96, v100
    s_nop 0
    v_permlane32_swap_b32 v104, v106
    v_permlane32_swap_b32 v105, v107
    s_mov_b64 exec, 0x11111111
    buffer_store_dwordx4 v[104:107], v110, s[4:7], s63 offen sc1
    s_mov_b64 exec, -1
    s_load_dwordx2 s[28:29], s[0:1], 80
    s_mov_b32 s30, 1152
    s_mov_b32 s31, 0x00020000
    s_lshl_b32 s47, s46, 5
    s_add_u32 s47, s47, s3
    s_lshl_b32 s47, s47, 15
    s_lshl_b32 s61, s45, 8
    s_add_u32 s47, s47, s61
    s_lshl_b32 s61, s3, 13
    s_waitcnt vmcnt(3)
    s_add_u32 m0, s61, 0
    s_add_u32 s64, s47, 0
    buffer_load_dwordx4 v20, s[20:23], s64 offen nt lds
    s_waitcnt vmcnt(3)
    s_add_u32 m0, s61, 1024
    s_add_u32 s64, s47, 8192
    buffer_load_dwordx4 v21, s[20:23], s64 offen nt lds
    s_waitcnt vmcnt(3)
    s_add_u32 m0, s61, 2048
    s_add_u32 s64, s47, 16384
    buffer_load_dwordx4 v20, s[20:23], s64 offen nt lds
    s_waitcnt vmcnt(3)
    s_add_u32 m0, s61, 3072
    s_add_u32 s64, s47, 24576
    buffer_load_dwordx4 v21, s[20:23], s64 offen nt lds
    s_waitcnt vmcnt(3)
    s_add_u32 m0, s61, 4096
    s_add_u32 s64, s47, 524288
    buffer_load_dwordx4 v20, s[20:23], s64 offen nt lds
    s_waitcnt vmcnt(3)
    s_add_u32 m0, s61, 5120
    s_add_u32 s64, s47, 532480
    buffer_load_dwordx4 v21, s[20:23], s64 offen nt lds
    s_waitcnt vmcnt(3)
    s_add_u32 m0, s61, 6144
    s_add_u32 s64, s47, 540672
    buffer_load_dwordx4 v20, s[20:23], s64 offen nt lds
    s_waitcnt vmcnt(3)
    s_add_u32 m0, s61, 7168
    s_add_u32 s64, s47, 548864
    buffer_load_dwordx4 v21, s[20:23], s64 offen nt lds
    s_mul_i32 s49, s44, 36864
    s_mul_i32 s48, s3, 9216
    s_add_u32 s48, s48, s49
    s_mul_i32 s64, s3, 9216
    s_add_u32 m0, s64, 35840
    s_nop 0
    buffer_load_dwordx4 v22, s[24:27], s48 offen nt lds
    s_add_u32 m0, s64, 36864
    s_nop 0
    buffer_load_dwordx4 v23, s[24:27], s48 offen nt lds
    s_add_u32 m0, s64, 37888
    s_nop 0
    buffer_load_dwordx4 v24, s[24:27], s48 offen nt lds
    s_add_u32 m0, s64, 38912
    s_nop 0
    buffer_load_dwordx4 v25, s[24:27], s48 offen nt lds
    s_add_u32 m0, s64, 39936
    s_nop 0
    buffer_load_dwordx4 v26, s[24:27], s48 offen nt lds
    s_add_u32 m0, s64, 40960
    s_nop 0
    buffer_load_dwordx4 v27, s[24:27], s48 offen nt lds
    s_add_u32 m0, s64, 41984
    s_nop 0
    buffer_load_dwordx4 v28, s[24:27], s48 offen nt lds
    s_add_u32 m0, s64, 43008
    s_nop 0
    buffer_load_dwordx4 v29, s[24:27], s48 offen nt lds
    s_add_u32 m0, s64, 44032
    s_nop 0
    buffer_load_dwordx4 v30, s[24:27], s48 offen nt lds
    s_sub_u32 s93, s46, 1
    s_lshl_b32 s93, s93, 5
    s_add_u32 s93, s93, s45
    v_mov_b32 v73, 0
    s_waitcnt lgkmcnt(0)
    s_cmp_lg_u32 s3, 0
    s_cbranch_scc1 L_A_nogate
    s_cmp_ge_u32 s93, 36
    s_cbranch_scc1 L_A_nogate
    v_and_b32 v4, 31, v1
    v_mul_u32_u24 v5, 36, v4
    v_lshrrev_b32 v6, 5, v1
    v_mul_u32_u24 v6, 1152, v6
    v_add_u32 v6, v6, v5
    buffer_load_dwordx4 v[48:51], v6, s[8:11], 0 offen
    buffer_load_dwordx4 v[52:55], v6, s[8:11], 0 offen offset:16
    buffer_load_dword v56, v6, s[8:11], 0 offen offset:32
    buffer_load_dwordx4 v[60:63], v5, s[32:35], 0 offen
    buffer_load_dwordx4 v[64:67], v5, s[32:35], 0 offen offset:16
    buffer_load_dword v68, v5, s[32:35], 0 offen offset:32
    s_cmp_ge_u32 s93, 32
    s_cbranch_scc1 L_A_uleft
    s_lshr_b32 s48, s93, 2
    s_lshl_b32 s48, s48, 4
    s_and_b32 s50, s93, 1
    s_lshl_b32 s50, s50, 3
    s_add_u32 s48, s48, s50
    v_and_b32 v5, 3, v4
    v_lshlrev_b32 v5, 7, v5
    v_lshrrev_b32 v6, 2, v4
    v_add3_u32 v5, v5, v6, s48
    s_bfe_u32 s50, s93, 0x10001
    v_mov_b32 v74, s50
    s_branch L_A_ujoin
L_A_uleft:
    s_lshl_b32 s48, s93, 4
    v_and_b32 v5, 15, v4
    v_add_u32 v5, s48, v5
    v_lshrrev_b32 v74, 4, v4
L_A_ujoin:
    v_lshlrev_b32 v5, 1, v5
    buffer_load_ushort v72, v5, s[28:31], 0 offen
    v_mul_u32_u24 v73, 1152, v74
    v_add_u32 v73, v73, v5
    buffer_load_ushort v253, v73, s[36:39], 0 offen
L_A_nogate:
    s_mul_i32 s47, s44, 16640
    s_add_u32 s47, s47, 4718592
    s_lshl_b32 s64, s3, 10
    s_add_u32 s63, s47, s64
    s_lshl_b32 s64, s3, 8
    s_add_u32 s47, s47, s64
    s_add_u32 s47, s47, 4096
    v_lshlrev_b32 v33, 2, v1
    v_lshlrev_b32 v39, 7, v3
    v_and_b32 v4, 1, v1
    v_lshl_add_u32 v39, v4, 6, v39
    v_bfe_u32 v4, v1, 1, 1
    v_lshl_add_u32 v39, v4, 9, v39
    s_lshl_b32 s61, s45, 2
    s_add_u32 s61, s61, s3
    s_lshl_b32 s61, s61, 6
    s_add_u32 s61, s61, s46
    s_lshl_b32 s61, s61, 4
    s_add_u32 s61, s61, 655360
    v_lshrrev_b32 v4, 2, v1
    v_bfe_u32 v5, v1, 1, 1
    v_lshl_add_u32 v5, s3, 2, v5
    v_and_b32 v6, 7, v4
    v_lshlrev_b32 v6, 1, v6
    v_xor_b32 v5, v5, v6
    v_lshlrev_b32 v34, 8, v4
    v_lshl_add_u32 v34, v5, 4, v34
    v_and_b32 v5, 1, v1
    v_lshl_add_u32 v34, v5, 3, v34
    v_xor_b32 v35, 32, v34
    v_lshrrev_b32 v4, 2, v1
    v_bfe_u32 v5, v1, 1, 1
    v_lshl_add_u32 v5, s3, 2, v5
    v_and_b32 v6, 6, v4
    v_xor_b32 v6, v6, v5
    v_lshlrev_b32 v6, 4, v6
    v_mul_u32_u24 v36, 1152, v4
    v_add_u32 v36, v36, v6
    v_and_b32 v6, 1, v1
    v_lshlrev_b32 v6, 3, v6
    v_add_u32 v36, v36, v6
    v_xor_b32 v37, 32, v36
    v_add_u32 v36, 35840, v36
    v_add_u32 v37, 35840, v37
    v_and_b32 v4, 1, v1
    v_lshlrev_b32 v38, 9, v4
    v_bfe_u32 v4, v1, 1, 1
    v_lshl_add_u32 v38, v4, 8, v38
    v_lshl_add_u32 v38, v3, 4, v38
    v_and_b32 v4, 1, v3
    v_lshlrev_b32 v46, 3, v4
    v_lshl_add_u32 v46, v2, 4, v46
    v_lshl_add_u32 v46, s3, 8, v46
    v_and_b32 v4, 7, v1
    v_lshlrev_b32 v40, 4, v4
    v_lshl_add_u32 v40, v3, 7, v40
    v_and_b32 v4, 31, v1
    v_lshlrev_b32 v41, 8, v4
    v_lshlrev_b32 v42, 10, v3
    v_lshl_add_u32 v42, v2, 4, v42
    v_lshlrev_b32 v43, 1, v4
    v_lshl_add_u32 v43, s3, 6, v43
    s_and_b32 s64, s3, 1
    s_lshl_b32 s64, s64, 5
    s_lshl_b32 s65, s3, 6
    s_add_u32 s64, s64, s65
    v_lshl_add_u32 v44, v3, 3, s64
    v_cmp_gt_u32 s[52:53], 8, v2
    s_waitcnt vmcnt(0)
    s_barrier
    s_lshr_b32 s48, s45, 4
    s_lshl_b32 s48, s48, 1
    s_lshr_b32 s50, s3, 1
    s_add_u32 s48, s48, s50
    s_lshl_b32 s48, s48, 13
    s_and_b32 s50, s45, 15
    s_lshl_b32 s50, s50, 4
    s_add_u32 s48, s48, s50
    s_add_u32 s49, s48, 163840
    s_add_u32 s48, s48, 131072
    buffer_load_dwordx4 v[88:91], v41, s[4:7], s48 offen sc1
    ds_read_b64_tr_b16 a[0:1], v34 offset:0
    ds_read_b64_tr_b16 a[2:3], v34 offset:4096
    ds_read_b64_tr_b16 a[4:5], v34 offset:8192
    ds_read_b64_tr_b16 a[6:7], v34 offset:12288
    ds_read_b64_tr_b16 a[8:9], v34 offset:16384
    ds_read_b64_tr_b16 a[10:11], v34 offset:20480
    ds_read_b64_tr_b16 a[12:13], v34 offset:24576
    ds_read_b64_tr_b16 a[14:15], v34 offset:28672
    ds_read_b64_tr_b16 a[16:17], v35 offset:0
    ds_read_b64_tr_b16 a[18:19], v35 offset:4096
    ds_read_b64_tr_b16 a[20:21], v35 offset:8192
    ds_read_b64_tr_b16 a[22:23], v35 offset:12288
    ds_read_b64_tr_b16 a[24:25], v35 offset:16384
    ds_read_b64_tr_b16 a[26:27], v35 offset:20480
    ds_read_b64_tr_b16 a[28:29], v35 offset:24576
    ds_read_b64_tr_b16 a[30:31], v35 offset:28672
    ds_read_b64_tr_b16 a[32:33], v36 offset:0
    ds_read_b64_tr_b16 a[34:35], v36 offset:18432
    ds_read_b64_tr_b16 a[36:37], v37 offset:0
    ds_read_b64_tr_b16 a[38:39], v37 offset:18432
    ds_read_b64_tr_b16 a[40:41], v36 offset:256
    ds_read_b64_tr_b16 a[42:43], v36 offset:18688
    ds_read_b64_tr_b16 a[44:45], v37 offset:256
    ds_read_b64_tr_b16 a[46:47], v37 offset:18688
    ds_read_b64_tr_b16 a[48:49], v36 offset:512
    ds_read_b64_tr_b16 a[50:51], v36 offset:18944
    ds_read_b64_tr_b16 a[52:53], v37 offset:512
    ds_read_b64_tr_b16 a[54:55], v37 offset:18944
    ds_read_b64_tr_b16 a[56:57], v36 offset:768
    ds_read_b64_tr_b16 a[58:59], v36 offset:19200
    ds_read_b64_tr_b16 a[60:61], v37 offset:768
    ds_read_b64_tr_b16 a[62:63], v37 offset:19200
    ds_read_b64_tr_b16 a[64:65], v36 offset:1024
    ds_read_b64_tr_b16 a[66:67], v36 offset:19456
    ds_read_b64_tr_b16 a[68:69], v37 offset:1024
    ds_read_b64_tr_b16 a[70:71], v37 offset:19456
    s_and_b32 s64, s3, 1
    s_lshl_b32 s64, s64, 12
    s_add_u32 s64, s64, s49
    s_add_u32 s34, s4, s64
    s_addc_u32 s35, s5, 0
    s_mul_i32 s50, s44, 16640
    s_lshl_b32 s64, s3, 12
    s_add_u32 s50, s50, s64
    s_add_u32 s50, s50, 4718592
    s_bitcmp1_b32 s40, 0
    s_cselect_b32 s32, 0x10001, 0
    s_mov_b32 s68, 0x10000
    s_mov_b32 s66, s40
    s_mov_b32 s67, s40
    v_mov_b32 v4, 0
    v_dot2_f32_bf16 v4, v48, v60, v4
    v_dot2_f32_bf16 v4, v49, v61, v4
    v_dot2_f32_bf16 v4, v50, v62, v4
    v_dot2_f32_bf16 v4, v51, v63, v4
    v_dot2_f32_bf16 v4, v52, v64, v4
    v_dot2_f32_bf16 v4, v53, v65, v4
    v_dot2_f32_bf16 v4, v54, v66, v4
    v_dot2_f32_bf16 v4, v55, v67, v4
    v_dot2_f32_bf16 v4, v56, v68, v4
    s_nop 2
    v_add_f32_dpp v4, v4, v4 row_ror:8 row_mask:0xf bank_mask:0xf
    s_nop 1
    v_add_f32_dpp v4, v4, v4 row_ror:4 row_mask:0xf bank_mask:0xf
    s_nop 1
    v_add_f32_dpp v4, v4, v4 row_ror:2 row_mask:0xf bank_mask:0xf
    s_nop 1
    v_add_f32_dpp v4, v4, v4 row_ror:1 row_mask:0xf bank_mask:0xf
    v_mov_b32 v5, v4
    s_nop 1
    v_permlane16_swap_b32 v4, v5
    v_add_f32 v4, v4, v5
    v_mul_f32 v4, 0xbfb8aa3b, v4
    v_exp_f32 v4, v4
    s_nop 0
    v_add_f32 v4, 1.0, v4
    v_rcp_f32 v4, v4
    v_cmp_eq_u32 vcc, 1, v74
    v_mov_b32 v5, v4
    s_nop 1
    v_permlane32_swap_b32 v4, v5
    v_cndmask_b32 v74, v4, v5, vcc
    v_lshlrev_b32 v72, 16, v72
    s_mov_b32 s51, 0
    s_waitcnt vmcnt(0)
    s_branch L_A_d2chk
L_A_d2poll:
    s_mov_b64 exec, vcc
    buffer_load_dwordx4 v[88:91], v41, s[4:7], s48 offen sc1
    s_add_u32 s51, s51, 1
    s_cmp_gt_u32 s51, 1048576
    s_waitcnt vmcnt(0)
    s_cbranch_scc1 L_A_d2done
L_A_d2chk:
    v_cmp_ne_u64 vcc, s[40:41], v[90:91]
    s_cbranch_vccnz L_A_d2poll
L_A_d2done:
    s_mov_b64 exec, -1
    v_max_f32_dpp v4, v88, v88 row_ror:8 row_mask:0xf bank_mask:0xf
    s_nop 1
    v_max_f32_dpp v4, v4, v4 row_ror:4 row_mask:0xf bank_mask:0xf
    s_nop 1
    v_max_f32_dpp v4, v4, v4 row_ror:2 row_mask:0xf bank_mask:0xf
    s_nop 1
    v_max_f32_dpp v4, v4, v4 row_ror:1 row_mask:0xf bank_mask:0xf
    v_mov_b32 v5, v4
    s_nop 1
    v_permlane16_swap_b32 v4, v5
    v_max_f32 v4, v4, v5
    v_sub_f32 v4, v88, v4
    v_exp_f32 v4, v4
    s_nop 0
    v_cvt_pk_bf16_f32 v4, v4, v4
    ds_write_b16 v43, v4 offset:33536
    ds_read_b64 v[132:133], v44 offset:33536
    v_and_b32 v141, 0xffff0000, v4
    s_mov_b32 s51, 0
    s_branch L_A_lgo
L_A_lpoll:
    buffer_load_dwordx4 v[92:95], v41, s[4:7], s49 offen sc1
    s_add_u32 s51, s51, 1
    s_cmp_gt_u32 s51, 1048576
    s_cbranch_scc1 L_A_lgo
L_A_lchk:
    s_waitcnt vmcnt(0)
    v_cmp_ne_u64 vcc, s[40:41], v[94:95]
    s_cbranch_vccnz L_A_lpoll
L_A_lgo:
    s_mov_b32 s51, 0
    buffer_load_dwordx4 v[92:95], v41, s[4:7], s49 offen sc1
    buffer_load_dwordx4 v[96:99], v42, s[4:7], s50 offen offset:0 sc1
    buffer_load_dwordx4 v[100:103], v42, s[4:7], s50 offen offset:256 sc1
    buffer_load_dwordx4 v[104:107], v42, s[4:7], s50 offen offset:512 sc1
    buffer_load_dwordx4 v[108:111], v42, s[4:7], s50 offen offset:768 sc1
    s_waitcnt lgkmcnt(0)
    v_perm_b32 v116, v132, v132, v12
    v_perm_b32 v117, v132, v132, v13
    v_perm_b32 v118, v132, v132, v14
    v_perm_b32 v119, v132, v132, v15
    v_perm_b32 v120, v132, v132, v16
    v_perm_b32 v121, v132, v132, v17
    v_perm_b32 v122, v132, v132, v18
    v_perm_b32 v123, v132, v132, v19
    v_perm_b32 v124, v133, v133, v12
    v_perm_b32 v125, v133, v133, v13
    v_perm_b32 v126, v133, v133, v14
    v_perm_b32 v127, v133, v133, v15
    v_perm_b32 v128, v133, v133, v16
    v_perm_b32 v129, v133, v133, v17
    v_perm_b32 v130, v133, v133, v18
    v_perm_b32 v131, v133, v133, v19
L_A_ocomb:
    v_mov_b32 v142, 0
    s_waitcnt vmcnt(4)
    v_mul_f32 v140, v141, v92
    v_cmp_ne_u64 s[58:59], s[40:41], v[94:95]
    s_nop 0
    v_add_f32_dpp v140, v140, v140 row_ror:8 row_mask:0xf bank_mask:0xf
    s_nop 1
    v_add_f32_dpp v140, v140, v140 row_ror:4 row_mask:0xf bank_mask:0xf
    s_nop 1
    v_add_f32_dpp v140, v140, v140 row_ror:2 row_mask:0xf bank_mask:0xf
    s_nop 1
    v_add_f32_dpp v140, v140, v140 row_ror:1 row_mask:0xf bank_mask:0xf
    v_mov_b32 v5, v140
    s_nop 1
    v_permlane16_swap_b32 v140, v5
    v_add_f32 v140, v140, v5
    v_rcp_f32 v140, v140
    s_waitcnt vmcnt(3)
    v_xor_b32 v96, s32, v96
    v_xor_b32 v97, s32, v97
    v_xor_b32 v98, s32, v98
    v_xor_b32 v99, s32, v99
    s_nop 1
    v_mfma_f32_16x16x32_bf16 v[136:139], v[116:119], v[96:99], 0
    s_waitcnt vmcnt(2)
    v_xor_b32 v100, s32, v100
    v_xor_b32 v101, s32, v101
    v_xor_b32 v102, s32, v102
    v_xor_b32 v103, s32, v103
    v_bitop3_b32 v142, v142, v96, s68 bitop3:0xf6
    v_bitop3_b32 v142, v142, v97, s68 bitop3:0xf6
    v_bitop3_b32 v142, v142, v98, s68 bitop3:0xf6
    v_bitop3_b32 v142, v142, v99, s68 bitop3:0xf6
    v_mfma_f32_16x16x32_bf16 v[136:139], v[120:123], v[100:103], v[136:139]
    s_waitcnt vmcnt(1)
    v_xor_b32 v104, s32, v104
    v_xor_b32 v105, s32, v105
    v_xor_b32 v106, s32, v106
    v_xor_b32 v107, s32, v107
    v_bitop3_b32 v142, v142, v100, s68 bitop3:0xf6
    v_bitop3_b32 v142, v142, v101, s68 bitop3:0xf6
    v_bitop3_b32 v142, v142, v102, s68 bitop3:0xf6
    v_bitop3_b32 v142, v142, v103, s68 bitop3:0xf6
    v_mfma_f32_16x16x32_bf16 v[136:139], v[124:127], v[104:107], v[136:139]
    s_waitcnt vmcnt(0)
    v_xor_b32 v108, s32, v108
    v_xor_b32 v109, s32, v109
    v_xor_b32 v110, s32, v110
    v_xor_b32 v111, s32, v111
    v_bitop3_b32 v142, v142, v104, s68 bitop3:0xf6
    v_bitop3_b32 v142, v142, v105, s68 bitop3:0xf6
    v_bitop3_b32 v142, v142, v106, s68 bitop3:0xf6
    v_bitop3_b32 v142, v142, v107, s68 bitop3:0xf6
    v_mfma_f32_16x16x32_bf16 v[136:139], v[128:131], v[108:111], v[136:139]
    v_bitop3_b32 v142, v142, v108, s68 bitop3:0xf6
    v_bitop3_b32 v142, v142, v109, s68 bitop3:0xf6
    v_bitop3_b32 v142, v142, v110, s68 bitop3:0xf6
    v_bitop3_b32 v142, v142, v111, s68 bitop3:0xf6
    v_and_b32 v142, 0x10001, v142
    v_cmp_ne_u32 vcc, 0, v142
    s_nop 0
    s_or_b64 vcc, vcc, s[58:59]
    s_cbranch_scc1 L_A_oslow
L_A_ook:
    v_mul_f32 v136, v140, v136
    v_mul_f32 v137, v140, v137
    v_mul_f32 v138, v140, v138
    v_mul_f32 v139, v140, v139
    v_cvt_pk_bf16_f32 v136, v136, v137
    v_cvt_pk_bf16_f32 v137, v138, v139
    ds_write_b64 v46, v[136:137] offset:33792
    s_waitcnt lgkmcnt(0)
    s_barrier
    ds_read_b128 v[80:83], v38 offset:33792
    ds_read_b128 v[84:87], v38 offset:33856
    ds_read_b128 v[88:91], v38 offset:33920
    ds_read_b128 v[92:95], v38 offset:33984
    s_lshl_b32 s50, s44, 10
    s_add_u32 s50, s50, 1703936
    s_add_u32 s48, s61, 1048576
    s_and_b32 s33, s40, 15
    s_getreg_b32 s95, hwreg(HW_REG_XCC_ID, 0, 4)
    s_mov_b32 s96, s40
    s_xor_b32 s97, s41, s95
    v_mov_b32 v115, s97
    s_xor_b32 s16, s3, 3
    s_or_b32 s16, s16, s46
    s_lshl_b32 s64, s45, 7
    s_add_u32 s64, s64, 65536
    v_lshl_add_u32 v58, v1, 12, s64
    s_waitcnt lgkmcnt(3)
    v_mfma_f32_16x16x32_bf16 v[96:99], a[0:3], v[80:83], 0
    v_mfma_f32_16x16x32_bf16 v[100:103], a[16:19], v[80:83], 0
    s_waitcnt lgkmcnt(2)
    v_mfma_f32_16x16x32_bf16 v[96:99], a[4:7], v[84:87], v[96:99]
    v_mfma_f32_16x16x32_bf16 v[100:103], a[20:23], v[84:87], v[100:103]
    s_waitcnt lgkmcnt(1)
    v_mfma_f32_16x16x32_bf16 v[96:99], a[8:11], v[88:91], v[96:99]
    v_mfma_f32_16x16x32_bf16 v[100:103], a[24:27], v[88:91], v[100:103]
    s_waitcnt lgkmcnt(0)
    v_mfma_f32_16x16x32_bf16 v[96:99], a[12:15], v[92:95], v[96:99]
    v_mfma_f32_16x16x32_bf16 v[100:103], a[28:31], v[92:95], v[100:103]
    s_nop 7
    v_cndmask_b32 v80, v96, v100, s[54:55]
    v_cndmask_b32 v84, v100, v96, s[54:55]
    v_cndmask_b32 v81, v97, v101, s[54:55]
    v_cndmask_b32 v85, v101, v97, s[54:55]
    v_cndmask_b32 v82, v98, v102, s[54:55]
    v_cndmask_b32 v86, v102, v98, s[54:55]
    v_cndmask_b32 v83, v99, v103, s[54:55]
    v_cndmask_b32 v87, v103, v99, s[54:55]
    v_add_f32_dpp v80, v84, v80 quad_perm:[2,3,0,1] row_mask:0xf bank_mask:0xf
    v_add_f32_dpp v81, v85, v81 quad_perm:[2,3,0,1] row_mask:0xf bank_mask:0xf
    v_add_f32_dpp v82, v86, v82 quad_perm:[2,3,0,1] row_mask:0xf bank_mask:0xf
    v_add_f32_dpp v83, v87, v83 quad_perm:[2,3,0,1] row_mask:0xf bank_mask:0xf
    v_cvt_pk_bf16_f32 v112, v80, v81
    v_cvt_pk_bf16_f32 v113, v82, v83
    s_mov_b32 exec_lo, 0x000f000f
    s_mov_b32 exec_hi, 0x000f000f
    buffer_store_dwordx4 v[112:115], v39, s[4:7], s48 offen
    s_mov_b64 exec, -1
    v_and_b32 v4, 7, v1
    v_lshlrev_b32 v57, 6, v4
    v_lshrrev_b32 v5, 3, v1
    v_mul_u32_u24 v59, 16640, v5
    v_lshl_add_u32 v59, v4, 4, v59
    v_lshrrev_b32 v4, 5, v1
    v_lshl_add_u32 v57, v4, 4, v57
    v_bfe_u32 v4, v1, 4, 1
    v_lshl_add_u32 v57, v4, 5, v57
    v_lshl_add_u32 v57, s3, 2, v57
    s_mov_b32 s51, 0
L_A_hbld:
    buffer_load_dwordx4 v[104:107], v40, s[4:7], s50 offen sc1
    buffer_load_dwordx4 v[108:111], v40, s[4:7], s50 offen offset:512 sc1
    s_waitcnt vmcnt(0)
    v_cmp_ne_u64 vcc, s[96:97], v[106:107]
    v_cmp_ne_u64 s[56:57], s[96:97], v[110:111]
    v_cndmask_b32 v116, 0, v104, s[52:53]
    v_cndmask_b32 v117, 0, v105, s[52:53]
    v_cndmask_b32 v118, 0, v108, s[52:53]
    v_cndmask_b32 v119, 0, v109, s[52:53]
    s_or_b64 vcc, vcc, s[56:57]
    s_cbranch_scc1 L_A_hbpoll
L_A_hbdone:
    s_cmp_lg_u32 s16, 0
    s_cbranch_scc1 L_A_nod3
    s_mov_b64 exec, 0xff
    buffer_store_dword v114, v58, s[4:7], 0 offen sc1
    s_mov_b64 exec, -1
L_A_nod3:
    v_cndmask_b32 v120, v104, 0, s[52:53]
    v_cndmask_b32 v121, v105, 0, s[52:53]
    v_cndmask_b32 v122, v108, 0, s[52:53]
    v_cndmask_b32 v123, v109, 0, s[52:53]
    v_mfma_f32_16x16x32_bf16 v[124:127], v[116:119], a[32:35], 0
    v_mfma_f32_16x16x32_bf16 v[128:131], v[116:119], a[40:43], 0
    v_mfma_f32_16x16x32_bf16 v[132:135], v[116:119], a[48:51], 0
    v_mfma_f32_16x16x32_bf16 v[136:139], v[116:119], a[56:59], 0
    v_mfma_f32_16x16x32_bf16 v[124:127], v[120:123], a[36:39], v[124:127]
    v_mfma_f32_16x16x32_bf16 v[128:131], v[120:123], a[44:47], v[128:131]
    v_mfma_f32_16x16x32_bf16 v[132:135], v[120:123], a[52:55], v[132:135]
    v_mfma_f32_16x16x32_bf16 v[136:139], v[120:123], a[60:63], v[136:139]
    v_mfma_f32_16x16x32_bf16 v[140:143], v[116:119], a[64:67], 0
    v_mfma_f32_16x16x32_bf16 v[140:143], v[120:123], a[68:71], v[140:143]
    s_nop 2
    v_pk_add_f32 v[124:125], v[124:125], v[126:127]
    v_pk_add_f32 v[128:129], v[128:129], v[130:131]
    v_pk_add_f32 v[132:133], v[132:133], v[134:135]
    v_pk_add_f32 v[136:137], v[136:137], v[138:139]
    v_add_f32 v80, v124, v125
    v_add_f32 v81, v128, v129
    v_add_f32 v82, v132, v133
    v_add_f32 v83, v136, v137
    v_and_or_b32 v80, v80, -16, s33
    v_and_or_b32 v81, v81, -16, s33
    v_and_or_b32 v82, v82, -16, s33
    v_and_or_b32 v83, v83, -16, s33
    buffer_store_dwordx4 v[80:83], v47, s[4:7], s63 offen sc1
    s_cmp_gt_u32 s3, 1
    s_cbranch_scc1 L_A_no5b
    v_pk_add_f32 v[140:141], v[140:141], v[142:143]
    v_add_f32 v140, v140, v141
    v_and_or_b32 v140, v140, -16, s33
    buffer_store_dword v140, v33, s[4:7], s47 offen sc1
L_A_no5b:
    v_mov_b32 v115, s41
    s_cmp_ge_u32 s93, 36
    s_cbranch_scc1 L_A_exit
    s_lshl_b32 s64, s42, 2
    s_add_u32 s64, s64, s3
    s_lshl_b32 s64, s64, 10
    s_add_u32 s64, s64, 65536
    s_add_u32 s34, s4, s64
    s_addc_u32 s35, s5, 0
    s_load_dword s16, s[34:35], 0 glc
    s_load_dword s17, s[34:35], 128 glc
    s_load_dword s18, s[34:35], 256 glc
    s_load_dword s19, s[34:35], 384 glc
    s_load_dword s20, s[34:35], 512 glc
    s_load_dword s21, s[34:35], 640 glc
    s_load_dword s22, s[34:35], 768 glc
    s_load_dword s23, s[34:35], 896 glc
    s_lshl_b32 s49, s3, 12
    s_mul_i32 s50, s93, 16640
    s_add_u32 s49, s49, s50
    s_add_u32 s49, s49, 2097152
    s_mul_i32 s48, s3, 532480
    s_lshl_b32 s64, s93, 7
    s_add_u32 s48, s48, s64
    s_add_u32 s48, s48, 4718592
    s_add_u32 s50, s48, 133120
    s_add_u32 s69, s48, 266240
    s_add_u32 s61, s48, 399360
    s_mov_b32 s51, 0
    s_branch L_A_d3chk
L_A_d3poll:
    s_load_dword s16, s[34:35], 0 glc
    s_load_dword s17, s[34:35], 128 glc
    s_load_dword s18, s[34:35], 256 glc
    s_load_dword s19, s[34:35], 384 glc
    s_load_dword s20, s[34:35], 512 glc
    s_load_dword s21, s[34:35], 640 glc
    s_load_dword s22, s[34:35], 768 glc
    s_load_dword s23, s[34:35], 896 glc
    s_add_u32 s51, s51, 1
    s_cmp_gt_u32 s51, 1048576
    s_cbranch_scc1 L_A_d3go
L_A_d3chk:
    s_waitcnt lgkmcnt(0)
    s_xor_b64 s[16:17], s[16:17], s[66:67]
    s_xor_b64 s[18:19], s[18:19], s[66:67]
    s_xor_b64 s[20:21], s[20:21], s[66:67]
    s_xor_b64 s[22:23], s[22:23], s[66:67]
    s_or_b64 s[16:17], s[16:17], s[18:19]
    s_or_b64 s[20:21], s[20:21], s[22:23]
    s_or_b64 s[16:17], s[16:17], s[20:21]
    s_cbranch_scc1 L_A_d3poll
L_A_d3go:
    s_mov_b32 s51, 0
    s_waitcnt vmcnt(0)
    buffer_load_dwordx4 v[160:163], v47, s[4:7], s49 offen offset:0 sc1
    buffer_load_dwordx4 v[164:167], v47, s[4:7], s49 offen offset:1024 sc1
    buffer_load_dwordx4 v[168:171], v47, s[4:7], s49 offen offset:2048 sc1
    buffer_load_dwordx4 v[172:175], v47, s[4:7], s49 offen offset:3072 sc1
    buffer_load_dwordx4 v[144:147], v59, s[4:7], s48 offen sc1
    buffer_load_dwordx4 v[148:151], v59, s[4:7], s50 offen sc1
    buffer_load_dwordx4 v[152:155], v59, s[4:7], s69 offen sc1
    buffer_load_dwordx4 v[156:159], v59, s[4:7], s61 offen sc1
    s_waitcnt vmcnt(4)
    v_xor_b32 v160, s33, v160
    v_xor_b32 v161, s33, v161
    v_xor_b32 v162, s33, v162
    v_xor_b32 v163, s33, v163
    v_or3_b32 v142, v160, v161, v162
    v_or_b32 v142, v142, v163
    v_xor_b32 v164, s33, v164
    v_xor_b32 v165, s33, v165
    v_xor_b32 v166, s33, v166
    v_xor_b32 v167, s33, v167
    v_pk_add_f32 v[124:125], v[160:161], v[164:165]
    v_pk_add_f32 v[126:127], v[162:163], v[166:167]
    v_or3_b32 v142, v142, v164, v165
    v_or3_b32 v142, v142, v166, v167
    v_xor_b32 v168, s33, v168
    v_xor_b32 v169, s33, v169
    v_xor_b32 v170, s33, v170
    v_xor_b32 v171, s33, v171
    v_pk_add_f32 v[124:125], v[124:125], v[168:169]
    v_pk_add_f32 v[126:127], v[126:127], v[170:171]
    v_or3_b32 v142, v142, v168, v169
    v_or3_b32 v142, v142, v170, v171
    v_xor_b32 v172, s33, v172
    v_xor_b32 v173, s33, v173
    v_xor_b32 v174, s33, v174
    v_xor_b32 v175, s33, v175
    v_pk_add_f32 v[124:125], v[124:125], v[172:173]
    v_pk_add_f32 v[126:127], v[126:127], v[174:175]
    v_or3_b32 v142, v142, v172, v173
    v_or3_b32 v142, v142, v174, v175
    v_permlane32_swap_b32 v124, v125
    v_permlane32_swap_b32 v126, v127
    v_and_b32 v142, 15, v142
    v_add_f32 v124, v124, v125
    v_add_f32 v126, v126, v127
    v_cmp_ne_u32 vcc, 0, v142
    s_nop 0
    v_permlane16_swap_b32 v124, v126
    v_add_f32 v124, v124, v126
    s_mov_b64 s[56:57], vcc
    s_nop 0
    v_add_f32_dpp v124, v124, v124 row_ror:8 row_mask:0xf bank_mask:0xf
    ds_write_b32 v57, v124 offset:35328
L_A_r0sum:
    s_waitcnt vmcnt(3)
    v_xor_b32 v144, s33, v144
    v_xor_b32 v145, s33, v145
    v_xor_b32 v146, s33, v146
    v_xor_b32 v147, s33, v147
    v_or3_b32 v142, v144, v145, v146
    v_or_b32 v142, v142, v147
    s_waitcnt vmcnt(2)
    v_xor_b32 v148, s33, v148
    v_xor_b32 v149, s33, v149
    v_xor_b32 v150, s33, v150
    v_xor_b32 v151, s33, v151
    v_pk_add_f32 v[124:125], v[144:145], v[148:149]
    v_pk_add_f32 v[126:127], v[146:147], v[150:151]
    v_or3_b32 v142, v142, v148, v149
    v_or3_b32 v142, v142, v150, v151
    s_waitcnt vmcnt(1)
    v_xor_b32 v152, s33, v152
    v_xor_b32 v153, s33, v153
    v_xor_b32 v154, s33, v154
    v_xor_b32 v155, s33, v155
    v_pk_add_f32 v[124:125], v[124:125], v[152:153]
    v_pk_add_f32 v[126:127], v[126:127], v[154:155]
    v_or3_b32 v142, v142, v152, v153
    v_or3_b32 v142, v142, v154, v155
    s_waitcnt vmcnt(0)
    v_xor_b32 v156, s33, v156
    v_xor_b32 v157, s33, v157
    v_xor_b32 v158, s33, v158
    v_xor_b32 v159, s33, v159
    v_pk_add_f32 v[124:125], v[124:125], v[156:157]
    v_pk_add_f32 v[126:127], v[126:127], v[158:159]
    v_or3_b32 v142, v142, v156, v157
    v_or3_b32 v142, v142, v158, v159
    v_permlane32_swap_b32 v124, v125
    v_permlane32_swap_b32 v126, v127
    v_and_b32 v142, 15, v142
    v_add_f32 v124, v124, v125
    v_add_f32 v126, v126, v127
    v_cmp_ne_u32 vcc, 0, v142
    s_nop 0
    v_permlane16_swap_b32 v124, v126
    v_add_f32 v124, v124, v126
    s_cbranch_vccnz L_A_r0slow
L_A_r0ok:
    s_nop 0
    v_add_f32_dpp v124, v124, v124 row_ror:8 row_mask:0xf bank_mask:0xf
    ds_write_b32 v57, v124 offset:34816
    s_cmp_lg_u64 s[56:57], 0
    s_cbranch_scc1 L_A_r1slow
L_A_r1ok:
    s_waitcnt lgkmcnt(0)
    s_barrier
    s_cmp_lg_u32 s3, 0
    s_cbranch_scc1 L_A_exit
    s_mov_b32 exec_hi, 0
    ds_read_b128 v[144:147], v47 offset:34816
    ds_read_b128 v[148:151], v47 offset:35328
    v_sub_f32 v4, 1.0, v74
    s_waitcnt lgkmcnt(0)
    v_pk_add_f32 v[144:145], v[144:145], v[146:147]
    v_pk_add_f32 v[148:149], v[148:149], v[150:151]
    v_add_f32 v144, v144, v145
    v_add_f32 v148, v148, v149
    v_add_f32 v148, v148, v72
    v_mul_f32 v148, v4, v148
    v_fma_f32 v144, v74, v144, v148
    v_cvt_pk_bf16_f32 v144, v144, v144
    buffer_store_short v144, v73, s[36:39], 0 offen
    s_cmp_lg_u32 s93, 0
    s_cbranch_scc1 L_A_exit
    s_mov_b64 exec, 1
    buffer_store_dwordx2 v[114:115], v47, s[4:7], 0 offen offset:0
L_A_exit:
    s_endpgm
L_A_h0poll:
    s_add_u32 s51, s51, 1
    s_cmp_gt_u32 s51, 1048576
    s_cbranch_scc1 L_A_h0done
    s_cmp_lg_u32 s51, 8
    s_cbranch_scc1 L_A_h0ns
    v_mov_b32 v201, s41
    v_mov_b32 v207, s41
    s_lshl_b32 s65, s44, 11
    s_add_u32 s65, s65, 786432
    buffer_store_dwordx4 v[200:203], v47, s[4:7], s65 offen sc1
    buffer_store_dwordx4 v[204:207], v47, s[4:7], s65 offen offset:1024 sc1
L_A_h0ns:
    s_and_b32 s64, s51, 14
    s_cmp_eq_u32 s64, 14
    s_cselect_b32 s64, 1048576, 0
    s_cselect_b32 s65, s95, 0
    s_xor_b32 s97, s97, s65
    s_xor_b32 s48, s48, s64
    s_xor_b32 s50, s50, s64
    s_xor_b32 s69, s69, s64
    buffer_load_dwordx4 v[56:59], v47, s[4:7], s48 offen sc1
    buffer_load_dwordx4 v[60:63], v47, s[4:7], s48 offen offset:1024 sc1
    buffer_load_dwordx4 v[64:67], v47, s[4:7], s50 offen sc1
    buffer_load_dwordx4 v[68:71], v47, s[4:7], s50 offen offset:1024 sc1
    buffer_load_dwordx4 v[72:75], v47, s[4:7], s69 offen sc1
    buffer_load_dwordx4 v[76:79], v47, s[4:7], s69 offen offset:1024 sc1
    s_waitcnt vmcnt(0)
    s_branch L_A_h0chk
L_A_oslow:
    s_add_u32 s51, s51, 1
    s_cmp_gt_u32 s51, 1048576
    s_cbranch_scc1 L_A_ook
    buffer_load_dwordx4 v[92:95], v41, s[4:7], s49 offen sc1
    buffer_load_dwordx4 v[96:99], v42, s[4:7], s50 offen offset:0 sc1
    buffer_load_dwordx4 v[100:103], v42, s[4:7], s50 offen offset:256 sc1
    buffer_load_dwordx4 v[104:107], v42, s[4:7], s50 offen offset:512 sc1
    buffer_load_dwordx4 v[108:111], v42, s[4:7], s50 offen offset:768 sc1
    s_waitcnt vmcnt(0)
    s_branch L_A_ocomb
L_A_hbpoll:
    s_add_u32 s51, s51, 1
    s_cmp_gt_u32 s51, 1048576
    s_cbranch_scc1 L_A_hbdone
    s_cmp_lg_u32 s51, 8
    s_cbranch_scc1 L_A_hbns
    v_mov_b32 v115, s41
    s_mov_b32 exec_lo, 0x000f000f
    s_mov_b32 exec_hi, 0x000f000f
    buffer_store_dwordx4 v[112:115], v39, s[4:7], s61 offen sc1
    s_mov_b64 exec, -1
L_A_hbns:
    s_and_b32 s64, s51, 14
    s_cmp_eq_u32 s64, 14
    s_cselect_b32 s64, 1048576, 0
    s_cselect_b32 s65, s95, 0
    s_xor_b32 s97, s97, s65
    s_xor_b32 s50, s50, s64
    s_branch L_A_hbld
L_A_r0slow:
    s_add_u32 s51, s51, 1
    s_cmp_gt_u32 s51, 1048576
    s_cbranch_scc1 L_A_r0ok
    buffer_load_dwordx4 v[144:147], v59, s[4:7], s48 offen sc1
    buffer_load_dwordx4 v[148:151], v59, s[4:7], s50 offen sc1
    buffer_load_dwordx4 v[152:155], v59, s[4:7], s69 offen sc1
    buffer_load_dwordx4 v[156:159], v59, s[4:7], s61 offen sc1
    s_branch L_A_r0sum
L_A_r1slow:
    s_add_u32 s51, s51, 1
    s_cmp_gt_u32 s51, 1048576
    s_cbranch_scc1 L_A_r1ok
    buffer_load_dwordx4 v[160:163], v47, s[4:7], s49 offen offset:0 sc1
    buffer_load_dwordx4 v[164:167], v47, s[4:7], s49 offen offset:1024 sc1
    buffer_load_dwordx4 v[168:171], v47, s[4:7], s49 offen offset:2048 sc1
    buffer_load_dwordx4 v[172:175], v47, s[4:7], s49 offen offset:3072 sc1
    s_waitcnt vmcnt(3)
    v_xor_b32 v160, s33, v160
    v_xor_b32 v161, s33, v161
    v_xor_b32 v162, s33, v162
    v_xor_b32 v163, s33, v163
    v_or3_b32 v142, v160, v161, v162
    v_or_b32 v142, v142, v163
    s_waitcnt vmcnt(2)
    v_xor_b32 v164, s33, v164
    v_xor_b32 v165, s33, v165
    v_xor_b32 v166, s33, v166
    v_xor_b32 v167, s33, v167
    v_pk_add_f32 v[124:125], v[160:161], v[164:165]
    v_pk_add_f32 v[126:127], v[162:163], v[166:167]
    v_or3_b32 v142, v142, v164, v165
    v_or3_b32 v142, v142, v166, v167
    s_waitcnt vmcnt(1)
    v_xor_b32 v168, s33, v168
    v_xor_b32 v169, s33, v169
    v_xor_b32 v170, s33, v170
    v_xor_b32 v171, s33, v171
    v_pk_add_f32 v[124:125], v[124:125], v[168:169]
    v_pk_add_f32 v[126:127], v[126:127], v[170:171]
    v_or3_b32 v142, v142, v168, v169
    v_or3_b32 v142, v142, v170, v171
    s_waitcnt vmcnt(0)
    v_xor_b32 v172, s33, v172
    v_xor_b32 v173, s33, v173
    v_xor_b32 v174, s33, v174
    v_xor_b32 v175, s33, v175
    v_pk_add_f32 v[124:125], v[124:125], v[172:173]
    v_pk_add_f32 v[126:127], v[126:127], v[174:175]
    v_or3_b32 v142, v142, v172, v173
    v_or3_b32 v142, v142, v174, v175
    v_permlane32_swap_b32 v124, v125
    v_permlane32_swap_b32 v126, v127
    v_and_b32 v142, 15, v142
    v_add_f32 v124, v124, v125
    v_add_f32 v126, v126, v127
    v_cmp_ne_u32 vcc, 0, v142
    s_nop 0
    v_permlane16_swap_b32 v124, v126
    v_add_f32 v124, v124, v126
    s_cbranch_vccnz L_A_r1slow
    s_nop 0
    v_add_f32_dpp v124, v124, v124 row_ror:8 row_mask:0xf bank_mask:0xf
    ds_write_b32 v57, v124 offset:35328
    s_branch L_A_r1ok
L_B_rest:
    s_load_dwordx2 s[20:21], s[0:1], 72
    s_mov_b32 s22, 5308416
    s_mov_b32 s23, 0x00020000
    s_load_dwordx2 s[24:25], s[0:1], 64
    s_mov_b32 s26, 9216
    s_mov_b32 s27, 0x00020000
    s_load_dwordx2 s[16:17], s[0:1], 56
    s_mov_b32 s18, 5308416
    s_mov_b32 s19, 0x00020000
    s_mov_b32 s10, 2304
    s_mov_b32 s11, 0x00020000
    s_and_b32 s44, s43, 1
    s_lshl_b32 s47, s42, 4
    s_add_u32 s47, s47, s43
    s_mov_b32 s60, s47
    s_mov_b32 s68, 4289068965
    v_mul_u32_u24 v13, 266240, v3
    v_lshl_add_u32 v13, v2, 4, v13
    s_lshl_b32 s61, s44, 6
    s_add_u32 s61, s61, s3
    s_mul_i32 s61, s61, 16640
    s_lshl_b32 s48, s46, 8
    s_add_u32 s61, s61, s48
    s_add_u32 s61, s61, 4718592
    s_lshl_b32 s59, s44, 6
    s_add_u32 s59, s59, s46
    s_lshl_b32 s59, s59, 8
    s_add_u32 s59, s59, 131072
    v_lshrrev_b32 v4, 3, v1
    v_mul_u32_u24 v14, 16640, v4
    v_and_b32 v4, 7, v1
    v_lshl_add_u32 v14, v4, 4, v14
    v_lshrrev_b32 v4, 5, v1
    v_mul_u32_u24 v15, 16640, v4
    v_and_b32 v4, 31, v1
    v_lshl_add_u32 v15, v4, 2, v15
    s_lshl_b32 s63, s60, 7
    s_add_u32 s63, s63, 2097152
    s_mul_i32 s62, s3, 133120
    s_add_u32 s62, s62, s63
    s_mul_i32 s64, s3, 33280
    s_add_u32 s63, s63, s64
    s_add_u32 s63, s63, 532480
    v_lshrrev_b32 v7, 3, v2
    v_and_b32 v6, 7, v2
    v_lshl_add_u32 v6, v6, 1, v7
    v_lshlrev_b32 v7, 3, v7
    v_xor_b32 v6, v6, v7
    v_xor_b32 v6, v6, v3
    v_lshlrev_b32 v6, 4, v6
    v_lshl_add_u32 v6, v2, 10, v6
    s_lshl_b32 s48, s3, 15
    s_add_u32 s48, s48, 23552
    v_xor_b32 v28, 0, v6
    v_add_u32 v24, s48, v28
    v_xor_b32 v29, 64, v6
    v_add_u32 v25, s48, v29
    v_xor_b32 v30, 128, v6
    v_add_u32 v26, s48, v30
    v_xor_b32 v31, 192, v6
    v_add_u32 v27, s48, v31
    v_lshrrev_b32 v4, 2, v1
    v_lshrrev_b32 v7, 3, v4
    v_and_b32 v6, 7, v4
    v_lshl_add_u32 v6, v6, 1, v7
    v_lshlrev_b32 v7, 3, v7
    v_xor_b32 v6, v6, v7
    v_bfe_u32 v7, v1, 1, 1
    v_xor_b32 v6, v6, v7
    v_lshlrev_b32 v5, 10, v4
    v_lshl_add_u32 v5, v6, 4, v5
    v_and_b32 v7, 1, v1
    v_lshl_add_u32 v5, v7, 3, v5
    v_lshl_add_u32 v5, s3, 8, v5
    s_add_u32 s48, s3, 0
    s_and_b32 s48, s48, 3
    v_lshl_add_u32 v41, s48, 10, v12
    s_lshl_b32 s48, s48, 15
    s_add_u32 s48, s48, 23552
    v_add_u32 v16, s48, v5
    s_add_u32 s48, s3, 1
    s_and_b32 s48, s48, 3
    v_lshl_add_u32 v20, s48, 10, v12
    s_lshl_b32 s48, s48, 15
    s_add_u32 s48, s48, 23552
    v_add_u32 v17, s48, v5
    s_add_u32 s48, s3, 2
    s_and_b32 s48, s48, 3
    v_lshl_add_u32 v21, s48, 10, v12
    s_lshl_b32 s48, s48, 15
    s_add_u32 s48, s48, 23552
    v_add_u32 v18, s48, v5
    s_add_u32 s48, s3, 3
    s_and_b32 s48, s48, 3
    v_lshl_add_u32 v23, s48, 10, v12
    s_lshl_b32 s48, s48, 15
    s_add_u32 s48, s48, 23552
    v_add_u32 v19, s48, v5
    v_lshlrev_b32 v39, 4, v2
    v_lshl_add_u32 v38, v3, 2, v39
    v_lshl_add_u32 v38, s3, 8, v38
    s_lshl_b32 s33, s45, 1
    s_add_u32 s33, s33, s44
    s_lshl_b32 s33, s33, 2
    s_add_u32 s33, s33, s3
    s_lshl_b32 s33, s33, 12
    s_add_u32 s33, s33, 524288
    s_lshr_b32 s64, s3, 1
    s_xor_b32 s65, s3, s64
    s_and_b32 s65, s65, 1
    s_lshl_b32 s65, s65, 3
    s_add_u32 s64, s64, s65
    s_lshl_b32 s64, s64, 4
    v_xor_b32 v8, s64, v12
    v_xor_b32 v9, 32, v8
    v_xor_b32 v10, 64, v8
    v_xor_b32 v11, 0x60, v8
    v_mov_b32 v4, 0
    v_lshlrev_b32 v5, 2, v1
    s_mov_b32 exec_hi, 0
    ds_write_b32 v5, v4 offset:21760
    s_mov_b64 exec, -1
    s_lshl_b32 s64, s42, 3
    s_lshl_b32 s65, s44, 2
    s_add_u32 s64, s64, s65
    s_add_u32 s64, s64, s3
    s_lshl_b32 s64, s64, 9
    s_add_u32 s64, s64, 32768
    s_add_u32 s34, s4, s64
    s_addc_u32 s35, s5, 0
    v_add_u32 v4, 0, v1
    v_mul_u32_u24 v5, 911, v4
    v_lshrrev_b32 v5, 16, v5
    v_and_b32 v42, 6, v5
    v_xor_b32 v42, v42, v4
    v_lshlrev_b32 v42, 4, v42
    v_add_u32 v4, 64, v1
    v_mul_u32_u24 v5, 911, v4
    v_lshrrev_b32 v5, 16, v5
    v_and_b32 v43, 6, v5
    v_xor_b32 v43, v43, v4
    v_lshlrev_b32 v43, 4, v43
    v_add_u32 v4, 128, v1
    v_mul_u32_u24 v5, 911, v4
    v_lshrrev_b32 v5, 16, v5
    v_and_b32 v44, 6, v5
    v_xor_b32 v44, v44, v4
    v_lshlrev_b32 v44, 4, v44
    v_add_u32 v4, 192, v1
    v_mul_u32_u24 v5, 911, v4
    v_lshrrev_b32 v5, 16, v5
    v_and_b32 v45, 6, v5
    v_xor_b32 v45, v45, v4
    v_lshlrev_b32 v45, 4, v45
    v_add_u32 v4, 256, v1
    v_mul_u32_u24 v5, 911, v4
    v_lshrrev_b32 v5, 16, v5
    v_and_b32 v46, 6, v5
    v_xor_b32 v46, v46, v4
    v_lshlrev_b32 v46, 4, v46
    v_add_u32 v4, 320, v1
    v_mul_u32_u24 v5, 911, v4
    v_lshrrev_b32 v5, 16, v5
    v_and_b32 v47, 6, v5
    v_xor_b32 v47, v47, v4
    v_lshlrev_b32 v47, 4, v47
    v_add_u32 v4, 384, v1
    v_mul_u32_u24 v5, 911, v4
    v_lshrrev_b32 v5, 16, v5
    v_and_b32 v48, 6, v5
    v_xor_b32 v48, v48, v4
    v_lshlrev_b32 v48, 4, v48
    v_add_u32 v4, 448, v1
    v_mul_u32_u24 v5, 911, v4
    v_lshrrev_b32 v5, 16, v5
    v_and_b32 v49, 6, v5
    v_xor_b32 v49, v49, v4
    v_lshlrev_b32 v49, 4, v49
    v_add_u32 v4, 512, v1
    v_mul_u32_u24 v5, 911, v4
    v_lshrrev_b32 v5, 16, v5
    v_and_b32 v50, 6, v5
    v_xor_b32 v50, v50, v4
    v_lshlrev_b32 v50, 4, v50
    v_lshl_add_u32 v4, s3, 6, v1
    v_mul_u32_u24 v5, 911, v4
    v_lshrrev_b32 v5, 16, v5
    v_and_b32 v51, 6, v5
    v_xor_b32 v51, v51, v4
    v_lshlrev_b32 v51, 4, v51
    v_lshrrev_b32 v4, 2, v1
    v_bfe_u32 v5, v1, 1, 1
    v_lshl_add_u32 v5, s3, 2, v5
    v_and_b32 v6, 6, v4
    v_xor_b32 v6, v6, v5
    v_lshlrev_b32 v6, 4, v6
    v_mul_u32_u24 v52, 1152, v4
    v_add_u32 v52, v52, v6
    v_and_b32 v6, 1, v1
    v_lshlrev_b32 v6, 3, v6
    v_add_u32 v52, v52, v6
    v_xor_b32 v53, 32, v52
    v_add_u32 v52, 23552, v52
    v_add_u32 v53, 23552, v53
    v_and_b32 v4, 3, v4
    v_and_b32 v54, 2, v4
    v_xor_b32 v54, v54, v5
    v_lshlrev_b32 v54, 4, v54
    v_mul_u32_u24 v4, 1152, v4
    v_add3_u32 v54, v54, v4, v6
    v_xor_b32 v55, 32, v54
    v_add_u32 v54, 60416, v54
    v_add_u32 v55, 60416, v55
    v_bfe_u32 v4, v1, 2, 1
    v_lshlrev_b32 v4, 7, v4
    v_add_u32 v4, 21504, v4
    v_lshl_add_u32 v5, v3, 3, v4
    v_add_u32 v4, 64, v4
    v_mov_b32 v6, 21760
    v_cmp_gt_u32 vcc, 8, v2
    s_nop 1
    v_cndmask_b32 v58, v6, v5, vcc
    v_cndmask_b32 v59, v5, v6, vcc
    v_lshrrev_b32 v5, 3, v1
    v_cmp_eq_u32 vcc, 0, v5
    s_nop 1
    v_cndmask_b32 v60, v6, v4, vcc
    v_cmp_eq_u32 vcc, 1, v5
    s_nop 1
    v_cndmask_b32 v61, v6, v4, vcc
    s_waitcnt lgkmcnt(0)
    s_add_u32 s40, s40, 2654435769
    s_add_u32 s41, s41, 2135587861
    v_mov_b32 v36, s40
    v_mov_b32 v37, s41
    s_bitcmp1_b32 s40, 0
    s_cselect_b32 s32, 1, 0x10000
    v_mov_b32 v35, s32
    s_mov_b32 s36, 0xfffefffe
    s_mov_b32 s66, s40
    s_mov_b32 s67, s40
    v_mov_b32 v33, s32
    s_lshl_b32 s48, s47, 2
    s_add_u32 s48, s48, s3
    s_mul_i32 s38, s48, 1821
    s_lshr_b32 s38, s38, 16
    s_mul_i32 s64, s38, 36
    s_sub_u32 s39, s48, s64
    s_min_u32 s64, s38, 4
    s_mul_i32 s56, s38, 10
    s_add_u32 s56, s56, s64
    s_lshl_b32 s56, s56, 2
    v_bfe_u32 v4, v1, 3, 1
    v_mul_u32_u24 v4, 1152, v4
    s_lshl_b32 s48, s56, 1
    buffer_load_dwordx4 v[64:67], v4, s[8:11], s48 offen offset:0
    buffer_load_dwordx4 v[68:71], v4, s[8:11], s48 offen offset:16
    buffer_load_dwordx4 v[72:75], v4, s[8:11], s48 offen offset:32
    buffer_load_dwordx4 v[76:79], v4, s[8:11], s48 offen offset:48
    buffer_load_dwordx4 v[80:83], v4, s[8:11], s48 offen offset:64
    buffer_load_dwordx2 v[84:85], v4, s[8:11], s48 offen offset:80
    v_mul_u32_u24 v164, 9216, v3
    v_lshl_add_u32 v164, v2, 4, v164
    v_lshrrev_b32 v4, 5, v1
    v_mul_u32_u24 v165, 18432, v4
    v_and_b32 v4, 31, v1
    v_lshl_add_u32 v165, v4, 4, v165
    v_mul_u32_u24 v4, 0x0202, v3
    v_add_u32 v4, 0x0100, v4
    v_and_b32 v5, 1, v1
    v_lshlrev_b32 v5, 4, v5
    v_lshlrev_b32 v4, v5, v4
    v_mov_b32 v6, 0x0c0c0000
    v_lshrrev_b32 v6, v5, v6
    v_or_b32 v4, v4, v6
    v_bfe_u32 v5, v1, 1, 2
    v_mov_b32 v6, 0x0c0c0c0c
    v_cmp_eq_u32 vcc, 0, v5
    s_nop 1
    v_cndmask_b32 v88, v6, v4, vcc
    v_cmp_eq_u32 vcc, 1, v5
    s_nop 1
    v_cndmask_b32 v89, v6, v4, vcc
    v_cmp_eq_u32 vcc, 2, v5
    s_nop 1
    v_cndmask_b32 v90, v6, v4, vcc
    v_cmp_eq_u32 vcc, 3, v5
    s_nop 1
    v_cndmask_b32 v91, v6, v4, vcc
    v_lshrrev_b32 v4, 5, v1
    v_bfe_u32 v5, v1, 4, 1
    v_lshl_add_u32 v4, v5, 1, v4
    v_lshl_add_u32 v4, v2, 2, v4
    v_lshlrev_b32 v4, 1, v4
    s_mul_i32 s48, s47, 72
    buffer_load_ushort v22, v4, s[24:27], s48 offen
    v_lshl_add_u32 v57, s3, 7, v4
    s_mul_i32 s48, s47, 9
    v_add_u32 v4, s48, v2
    v_and_b32 v5, 1, v4
    v_lshlrev_b32 v5, 8, v5
    v_bfe_u32 v6, v4, 1, 4
    v_lshl_add_u32 v5, v6, 4, v5
    v_lshrrev_b32 v6, 5, v4
    v_lshl_add_u32 v5, v6, 9, v5
    v_mul_u32_u24 v56, 36864, v3
    v_add_u32 v56, v56, v5
    s_load_dwordx4 s[8:11], s[34:35], 0 glc
    s_load_dwordx4 s[12:15], s[34:35], 128 glc
    s_load_dwordx4 s[24:27], s[34:35], 256 glc
    s_load_dwordx4 s[52:55], s[34:35], 384 glc
    v_xor_b32 v4, 0, v12
    buffer_load_dwordx4 v4, s[28:31], s37 offen offset:0  lds
    v_xor_b32 v5, 32, v12
    buffer_load_dwordx4 v5, s[28:31], s37 offen offset:1024  lds
    v_xor_b32 v4, 64, v12
    buffer_load_dwordx4 v4, s[28:31], s37 offen offset:2048  lds
    v_xor_b32 v5, 96, v12
    buffer_load_dwordx4 v5, s[28:31], s37 offen offset:3072  lds
    s_addk_i32 s37, 4096
    s_add_u32 m0, m0, 0x1000
    v_xor_b32 v4, 128, v12
    buffer_load_dwordx4 v4, s[28:31], s37 offen offset:0  lds
    v_xor_b32 v5, 160, v12
    buffer_load_dwordx4 v5, s[28:31], s37 offen offset:1024  lds
    v_xor_b32 v4, 192, v12
    buffer_load_dwordx4 v4, s[28:31], s37 offen offset:2048  lds
    v_xor_b32 v5, 224, v12
    buffer_load_dwordx4 v5, s[28:31], s37 offen offset:3072  lds
    s_addk_i32 s37, 4096
    s_add_u32 m0, m0, 0x1000
    v_xor_b32 v4, 144, v12
    buffer_load_dwordx4 v4, s[28:31], s37 offen offset:0  lds
    v_xor_b32 v5, 176, v12
    buffer_load_dwordx4 v5, s[28:31], s37 offen offset:1024  lds
    v_xor_b32 v4, 208, v12
    buffer_load_dwordx4 v4, s[28:31], s37 offen offset:2048  lds
    v_xor_b32 v5, 240, v12
    buffer_load_dwordx4 v5, s[28:31], s37 offen offset:3072  lds
    s_addk_i32 s37, 4096
    s_add_u32 m0, m0, 0x1000
    v_xor_b32 v4, 16, v12
    buffer_load_dwordx4 v4, s[28:31], s37 offen offset:0  lds
    v_xor_b32 v5, 48, v12
    buffer_load_dwordx4 v5, s[28:31], s37 offen offset:1024  lds
    v_xor_b32 v4, 80, v12
    buffer_load_dwordx4 v4, s[28:31], s37 offen offset:2048  lds
    v_xor_b32 v5, 112, v12
    buffer_load_dwordx4 v5, s[28:31], s37 offen offset:3072  lds
    s_addk_i32 s37, 4096
    s_add_u32 m0, m0, 0x1000
    s_add_u32 s57, s56, 0
    s_mul_i32 s57, s57, 9216
    s_lshl_b32 s50, s39, 8
    s_add_u32 s57, s57, s50
    buffer_load_dwordx4 v[168:171], v164, s[16:19], s57 offen nt
    s_add_u32 s57, s57, 36864
    buffer_load_dwordx4 v[172:175], v164, s[16:19], s57 offen nt
    s_add_u32 s57, s57, 36864
    buffer_load_dwordx4 v[176:179], v164, s[16:19], s57 offen nt
    s_add_u32 s57, s57, 36864
    buffer_load_dwordx4 v[180:183], v164, s[16:19], s57 offen nt
    s_add_u32 s57, s57, 36864
    buffer_load_dwordx4 v[184:187], v164, s[16:19], s57 offen nt
    s_add_u32 s57, s57, 36864
    buffer_load_dwordx4 v[188:191], v164, s[16:19], s57 offen nt
    s_add_u32 s57, s57, 36864
    buffer_load_dwordx4 v[192:195], v164, s[16:19], s57 offen nt
    s_add_u32 s57, s57, 36864
    buffer_load_dwordx4 v[196:199], v164, s[16:19], s57 offen nt
    s_add_u32 s57, s57, 36864
    s_lshl_b32 m0, s3, 12
    s_waitcnt lgkmcnt(0)
    s_load_dwordx4 s[8:11], s[34:35], 0 glc
    s_load_dwordx4 s[12:15], s[34:35], 128 glc
    s_load_dwordx4 s[24:27], s[34:35], 256 glc
    s_load_dwordx4 s[52:55], s[34:35], 384 glc
    s_mov_b32 s58, 0
    s_waitcnt vmcnt(24)
    ds_read_b128 a[0:3], v24 offset:0
    ds_read_b128 a[4:7], v25 offset:0
    ds_read_b128 a[8:11], v26 offset:0
    ds_read_b128 a[12:15], v27 offset:0
    ds_read_b128 a[16:19], v24 offset:256
    ds_read_b128 a[20:23], v25 offset:256
    ds_read_b128 a[24:27], v26 offset:256
    ds_read_b128 a[28:31], v27 offset:256
    ds_read_b128 a[32:35], v24 offset:512
    ds_read_b128 a[36:39], v25 offset:512
    ds_read_b128 a[40:43], v26 offset:512
    ds_read_b128 a[44:47], v27 offset:512
    ds_read_b128 a[48:51], v24 offset:768
    ds_read_b128 a[52:55], v25 offset:768
    ds_read_b128 a[56:59], v26 offset:768
    ds_read_b128 a[60:63], v27 offset:768
    v_perm_b32 v212, v65, v64, v88
    v_perm_b32 v213, v65, v64, v89
    v_perm_b32 v214, v65, v64, v90
    v_perm_b32 v215, v65, v64, v91
    v_perm_b32 v216, v67, v66, v88
    v_perm_b32 v217, v67, v66, v89
    v_perm_b32 v218, v67, v66, v90
    v_perm_b32 v219, v67, v66, v91
    v_perm_b32 v220, v69, v68, v88
    v_perm_b32 v221, v69, v68, v89
    v_perm_b32 v222, v69, v68, v90
    v_perm_b32 v223, v69, v68, v91
    v_perm_b32 v224, v71, v70, v88
    v_perm_b32 v225, v71, v70, v89
    v_perm_b32 v226, v71, v70, v90
    v_perm_b32 v227, v71, v70, v91
    v_perm_b32 v228, v73, v72, v88
    v_perm_b32 v229, v73, v72, v89
    v_perm_b32 v230, v73, v72, v90
    v_perm_b32 v231, v73, v72, v91
    v_perm_b32 v232, v75, v74, v88
    v_perm_b32 v233, v75, v74, v89
    v_perm_b32 v234, v75, v74, v90
    v_perm_b32 v235, v75, v74, v91
    v_perm_b32 v236, v77, v76, v88
    v_perm_b32 v237, v77, v76, v89
    v_perm_b32 v238, v77, v76, v90
    v_perm_b32 v239, v77, v76, v91
    v_perm_b32 v240, v79, v78, v88
    v_perm_b32 v241, v79, v78, v89
    v_perm_b32 v242, v79, v78, v90
    v_perm_b32 v243, v79, v78, v91
    v_perm_b32 v244, v81, v80, v88
    v_perm_b32 v245, v81, v80, v89
    v_perm_b32 v246, v81, v80, v90
    v_perm_b32 v247, v81, v80, v91
    v_perm_b32 v248, v83, v82, v88
    v_perm_b32 v249, v83, v82, v89
    v_perm_b32 v250, v83, v82, v90
    v_perm_b32 v251, v83, v82, v91
    v_perm_b32 v252, v85, v84, v88
    v_perm_b32 v253, v85, v84, v89
    v_perm_b32 v254, v85, v84, v90
    v_perm_b32 v255, v85, v84, v91
    s_cmp_lg_u32 s58, 0
    s_cbranch_scc1 L_B_cw1
    s_waitcnt vmcnt(8)
L_B_cw1:
    s_waitcnt vmcnt(12)
    ds_read_b128 a[64:67], v24 offset:16384
    ds_read_b128 a[68:71], v25 offset:16384
    ds_read_b128 a[72:75], v26 offset:16384
    ds_read_b128 a[76:79], v27 offset:16384
    ds_read_b128 a[80:83], v24 offset:16640
    ds_read_b128 a[84:87], v25 offset:16640
    ds_read_b128 a[88:91], v26 offset:16640
    ds_read_b128 a[92:95], v27 offset:16640
    ds_read_b128 a[96:99], v24 offset:16896
    ds_read_b128 a[100:103], v25 offset:16896
    ds_read_b128 a[104:107], v26 offset:16896
    ds_read_b128 a[108:111], v27 offset:16896
    ds_read_b128 a[112:115], v24 offset:17152
    ds_read_b128 a[116:119], v25 offset:17152
    ds_read_b128 a[120:123], v26 offset:17152
    ds_read_b128 a[124:127], v27 offset:17152
    s_barrier
    s_cmp_lg_u32 s58, 0
    s_cbranch_scc1 L_B_lkc0
    s_waitcnt lgkmcnt(0)
    s_xor_b64 s[8:9], s[8:9], s[66:67]
    s_xor_b64 s[10:11], s[10:11], s[66:67]
    s_or_b64 s[8:9], s[8:9], s[10:11]
    s_xor_b64 s[12:13], s[12:13], s[66:67]
    s_xor_b64 s[14:15], s[14:15], s[66:67]
    s_or_b64 s[12:13], s[12:13], s[14:15]
    s_xor_b64 s[24:25], s[24:25], s[66:67]
    s_xor_b64 s[26:27], s[26:27], s[66:67]
    s_or_b64 s[24:25], s[24:25], s[26:27]
    s_xor_b64 s[52:53], s[52:53], s[66:67]
    s_xor_b64 s[54:55], s[54:55], s[66:67]
    s_or_b64 s[52:53], s[52:53], s[54:55]
    s_or_b64 s[8:9], s[8:9], s[12:13]
    s_or_b64 s[24:25], s[24:25], s[52:53]
    s_or_b64 s[8:9], s[8:9], s[24:25]
    s_cbranch_scc1 L_B_lpc0
    buffer_load_dwordx4 v8, s[4:7], s33 offen offset:0 sc1 lds
    buffer_load_dwordx4 v9, s[4:7], s33 offen offset:1024 sc1 lds
    buffer_load_dwordx4 v10, s[4:7], s33 offen offset:2048 sc1 lds
    buffer_load_dwordx4 v11, s[4:7], s33 offen offset:3072 sc1 lds
    s_mov_b32 s58, 1
    s_branch L_B_lkc0
L_B_lpc0:
    s_load_dwordx4 s[8:11], s[34:35], 0 glc
    s_load_dwordx4 s[12:15], s[34:35], 128 glc
    s_load_dwordx4 s[24:27], s[34:35], 256 glc
    s_load_dwordx4 s[52:55], s[34:35], 384 glc
L_B_lkc0:
    v_xor_b32 v4, 0, v16
    ds_read_b64_tr_b16 a[128:129], v4 offset:0
    ds_read_b64_tr_b16 a[130:131], v4 offset:16384
    v_xor_b32 v5, 32, v16
    ds_read_b64_tr_b16 a[144:145], v5 offset:0
    ds_read_b64_tr_b16 a[146:147], v5 offset:16384
    v_xor_b32 v4, 64, v16
    ds_read_b64_tr_b16 a[160:161], v4 offset:0
    ds_read_b64_tr_b16 a[162:163], v4 offset:16384
    v_xor_b32 v5, 96, v16
    ds_read_b64_tr_b16 a[176:177], v5 offset:0
    ds_read_b64_tr_b16 a[178:179], v5 offset:16384
    v_xor_b32 v4, 128, v16
    ds_read_b64_tr_b16 a[192:193], v4 offset:0
    ds_read_b64_tr_b16 a[194:195], v4 offset:16384
    v_xor_b32 v5, 160, v16
    ds_read_b64_tr_b16 a[208:209], v5 offset:0
    ds_read_b64_tr_b16 a[210:211], v5 offset:16384
    v_xor_b32 v4, 192, v16
    ds_read_b64_tr_b16 a[224:225], v4 offset:0
    ds_read_b64_tr_b16 a[226:227], v4 offset:16384
    v_xor_b32 v5, 224, v16
    ds_read_b64_tr_b16 a[240:241], v5 offset:0
    ds_read_b64_tr_b16 a[242:243], v5 offset:16384
    s_cmp_lg_u32 s58, 0
    s_cbranch_scc1 L_B_lkc1
    s_waitcnt lgkmcnt(0)
    s_xor_b64 s[8:9], s[8:9], s[66:67]
    s_xor_b64 s[10:11], s[10:11], s[66:67]
    s_or_b64 s[8:9], s[8:9], s[10:11]
    s_xor_b64 s[12:13], s[12:13], s[66:67]
    s_xor_b64 s[14:15], s[14:15], s[66:67]
    s_or_b64 s[12:13], s[12:13], s[14:15]
    s_xor_b64 s[24:25], s[24:25], s[66:67]
    s_xor_b64 s[26:27], s[26:27], s[66:67]
    s_or_b64 s[24:25], s[24:25], s[26:27]
    s_xor_b64 s[52:53], s[52:53], s[66:67]
    s_xor_b64 s[54:55], s[54:55], s[66:67]
    s_or_b64 s[52:53], s[52:53], s[54:55]
    s_or_b64 s[8:9], s[8:9], s[12:13]
    s_or_b64 s[24:25], s[24:25], s[52:53]
    s_or_b64 s[8:9], s[8:9], s[24:25]
    s_cbranch_scc1 L_B_lpc1
    buffer_load_dwordx4 v8, s[4:7], s33 offen offset:0 sc1 lds
    buffer_load_dwordx4 v9, s[4:7], s33 offen offset:1024 sc1 lds
    buffer_load_dwordx4 v10, s[4:7], s33 offen offset:2048 sc1 lds
    buffer_load_dwordx4 v11, s[4:7], s33 offen offset:3072 sc1 lds
    s_mov_b32 s58, 1
    s_branch L_B_lkc1
L_B_lpc1:
    s_load_dwordx4 s[8:11], s[34:35], 0 glc
    s_load_dwordx4 s[12:15], s[34:35], 128 glc
    s_load_dwordx4 s[24:27], s[34:35], 256 glc
    s_load_dwordx4 s[52:55], s[34:35], 384 glc
L_B_lkc1:
    v_xor_b32 v4, 0, v17
    ds_read_b64_tr_b16 a[132:133], v4 offset:0
    ds_read_b64_tr_b16 a[134:135], v4 offset:16384
    v_xor_b32 v5, 32, v17
    ds_read_b64_tr_b16 a[148:149], v5 offset:0
    ds_read_b64_tr_b16 a[150:151], v5 offset:16384
    v_xor_b32 v4, 64, v17
    ds_read_b64_tr_b16 a[164:165], v4 offset:0
    ds_read_b64_tr_b16 a[166:167], v4 offset:16384
    v_xor_b32 v5, 96, v17
    ds_read_b64_tr_b16 a[180:181], v5 offset:0
    ds_read_b64_tr_b16 a[182:183], v5 offset:16384
    v_xor_b32 v4, 128, v17
    ds_read_b64_tr_b16 a[196:197], v4 offset:0
    ds_read_b64_tr_b16 a[198:199], v4 offset:16384
    v_xor_b32 v5, 160, v17
    ds_read_b64_tr_b16 a[212:213], v5 offset:0
    ds_read_b64_tr_b16 a[214:215], v5 offset:16384
    v_xor_b32 v4, 192, v17
    ds_read_b64_tr_b16 a[228:229], v4 offset:0
    ds_read_b64_tr_b16 a[230:231], v4 offset:16384
    v_xor_b32 v5, 224, v17
    ds_read_b64_tr_b16 a[244:245], v5 offset:0
    ds_read_b64_tr_b16 a[246:247], v5 offset:16384
    s_cmp_lg_u32 s58, 0
    s_cbranch_scc1 L_B_lkc2
    s_waitcnt lgkmcnt(0)
    s_xor_b64 s[8:9], s[8:9], s[66:67]
    s_xor_b64 s[10:11], s[10:11], s[66:67]
    s_or_b64 s[8:9], s[8:9], s[10:11]
    s_xor_b64 s[12:13], s[12:13], s[66:67]
    s_xor_b64 s[14:15], s[14:15], s[66:67]
    s_or_b64 s[12:13], s[12:13], s[14:15]
    s_xor_b64 s[24:25], s[24:25], s[66:67]
    s_xor_b64 s[26:27], s[26:27], s[66:67]
    s_or_b64 s[24:25], s[24:25], s[26:27]
    s_xor_b64 s[52:53], s[52:53], s[66:67]
    s_xor_b64 s[54:55], s[54:55], s[66:67]
    s_or_b64 s[52:53], s[52:53], s[54:55]
    s_or_b64 s[8:9], s[8:9], s[12:13]
    s_or_b64 s[24:25], s[24:25], s[52:53]
    s_or_b64 s[8:9], s[8:9], s[24:25]
    s_cbranch_scc1 L_B_lpc2
    buffer_load_dwordx4 v8, s[4:7], s33 offen offset:0 sc1 lds
    buffer_load_dwordx4 v9, s[4:7], s33 offen offset:1024 sc1 lds
    buffer_load_dwordx4 v10, s[4:7], s33 offen offset:2048 sc1 lds
    buffer_load_dwordx4 v11, s[4:7], s33 offen offset:3072 sc1 lds
    s_mov_b32 s58, 1
    s_branch L_B_lkc2
L_B_lpc2:
    s_load_dwordx4 s[8:11], s[34:35], 0 glc
    s_load_dwordx4 s[12:15], s[34:35], 128 glc
    s_load_dwordx4 s[24:27], s[34:35], 256 glc
    s_load_dwordx4 s[52:55], s[34:35], 384 glc
L_B_lkc2:
    v_xor_b32 v4, 0, v18
    ds_read_b64_tr_b16 a[136:137], v4 offset:0
    ds_read_b64_tr_b16 a[138:139], v4 offset:16384
    v_xor_b32 v5, 32, v18
    ds_read_b64_tr_b16 a[152:153], v5 offset:0
    ds_read_b64_tr_b16 a[154:155], v5 offset:16384
    v_xor_b32 v4, 64, v18
    ds_read_b64_tr_b16 a[168:169], v4 offset:0
    ds_read_b64_tr_b16 a[170:171], v4 offset:16384
    v_xor_b32 v5, 96, v18
    ds_read_b64_tr_b16 a[184:185], v5 offset:0
    ds_read_b64_tr_b16 a[186:187], v5 offset:16384
    v_xor_b32 v4, 128, v18
    ds_read_b64_tr_b16 a[200:201], v4 offset:0
    ds_read_b64_tr_b16 a[202:203], v4 offset:16384
    v_xor_b32 v5, 160, v18
    ds_read_b64_tr_b16 a[216:217], v5 offset:0
    ds_read_b64_tr_b16 a[218:219], v5 offset:16384
    v_xor_b32 v4, 192, v18
    ds_read_b64_tr_b16 a[232:233], v4 offset:0
    ds_read_b64_tr_b16 a[234:235], v4 offset:16384
    v_xor_b32 v5, 224, v18
    ds_read_b64_tr_b16 a[248:249], v5 offset:0
    ds_read_b64_tr_b16 a[250:251], v5 offset:16384
    s_cmp_lg_u32 s58, 0
    s_cbranch_scc1 L_B_lkc3
    s_waitcnt lgkmcnt(0)
    s_xor_b64 s[8:9], s[8:9], s[66:67]
    s_xor_b64 s[10:11], s[10:11], s[66:67]
    s_or_b64 s[8:9], s[8:9], s[10:11]
    s_xor_b64 s[12:13], s[12:13], s[66:67]
    s_xor_b64 s[14:15], s[14:15], s[66:67]
    s_or_b64 s[12:13], s[12:13], s[14:15]
    s_xor_b64 s[24:25], s[24:25], s[66:67]
    s_xor_b64 s[26:27], s[26:27], s[66:67]
    s_or_b64 s[24:25], s[24:25], s[26:27]
    s_xor_b64 s[52:53], s[52:53], s[66:67]
    s_xor_b64 s[54:55], s[54:55], s[66:67]
    s_or_b64 s[52:53], s[52:53], s[54:55]
    s_or_b64 s[8:9], s[8:9], s[12:13]
    s_or_b64 s[24:25], s[24:25], s[52:53]
    s_or_b64 s[8:9], s[8:9], s[24:25]
    s_cbranch_scc1 L_B_lpc3
    buffer_load_dwordx4 v8, s[4:7], s33 offen offset:0 sc1 lds
    buffer_load_dwordx4 v9, s[4:7], s33 offen offset:1024 sc1 lds
    buffer_load_dwordx4 v10, s[4:7], s33 offen offset:2048 sc1 lds
    buffer_load_dwordx4 v11, s[4:7], s33 offen offset:3072 sc1 lds
    s_mov_b32 s58, 1
    s_branch L_B_lkc3
L_B_lpc3:
    s_load_dwordx4 s[8:11], s[34:35], 0 glc
    s_load_dwordx4 s[12:15], s[34:35], 128 glc
    s_load_dwordx4 s[24:27], s[34:35], 256 glc
    s_load_dwordx4 s[52:55], s[34:35], 384 glc
L_B_lkc3:
    v_xor_b32 v4, 0, v19
    ds_read_b64_tr_b16 a[140:141], v4 offset:0
    ds_read_b64_tr_b16 a[142:143], v4 offset:16384
    v_xor_b32 v5, 32, v19
    ds_read_b64_tr_b16 a[156:157], v5 offset:0
    ds_read_b64_tr_b16 a[158:159], v5 offset:16384
    v_xor_b32 v4, 64, v19
    ds_read_b64_tr_b16 a[172:173], v4 offset:0
    ds_read_b64_tr_b16 a[174:175], v4 offset:16384
    v_xor_b32 v5, 96, v19
    ds_read_b64_tr_b16 a[188:189], v5 offset:0
    ds_read_b64_tr_b16 a[190:191], v5 offset:16384
    v_xor_b32 v4, 128, v19
    ds_read_b64_tr_b16 a[204:205], v4 offset:0
    ds_read_b64_tr_b16 a[206:207], v4 offset:16384
    v_xor_b32 v5, 160, v19
    ds_read_b64_tr_b16 a[220:221], v5 offset:0
    ds_read_b64_tr_b16 a[222:223], v5 offset:16384
    v_xor_b32 v4, 192, v19
    ds_read_b64_tr_b16 a[236:237], v4 offset:0
    ds_read_b64_tr_b16 a[238:239], v4 offset:16384
    v_xor_b32 v5, 224, v19
    ds_read_b64_tr_b16 a[252:253], v5 offset:0
    ds_read_b64_tr_b16 a[254:255], v5 offset:16384
    s_mov_b32 s51, 0
    s_cmp_lg_u32 s58, 0
    s_cbranch_scc1 L_B_qwait
    s_branch L_B_d1chk
L_B_d1poll:
    s_load_dwordx4 s[8:11], s[34:35], 0 glc
    s_load_dwordx4 s[12:15], s[34:35], 128 glc
    s_load_dwordx4 s[24:27], s[34:35], 256 glc
    s_load_dwordx4 s[52:55], s[34:35], 384 glc
    s_add_u32 s51, s51, 1
    s_cmp_gt_u32 s51, 1048576
    s_cbranch_scc1 L_B_qget0
L_B_d1chk:
    s_waitcnt lgkmcnt(0)
    s_xor_b64 s[8:9], s[8:9], s[66:67]
    s_xor_b64 s[10:11], s[10:11], s[66:67]
    s_or_b64 s[8:9], s[8:9], s[10:11]
    s_xor_b64 s[12:13], s[12:13], s[66:67]
    s_xor_b64 s[14:15], s[14:15], s[66:67]
    s_or_b64 s[12:13], s[12:13], s[14:15]
    s_xor_b64 s[24:25], s[24:25], s[66:67]
    s_xor_b64 s[26:27], s[26:27], s[66:67]
    s_or_b64 s[24:25], s[24:25], s[26:27]
    s_xor_b64 s[52:53], s[52:53], s[66:67]
    s_xor_b64 s[54:55], s[54:55], s[66:67]
    s_or_b64 s[52:53], s[52:53], s[54:55]
    s_or_b64 s[8:9], s[8:9], s[12:13]
    s_or_b64 s[24:25], s[24:25], s[52:53]
    s_or_b64 s[8:9], s[8:9], s[24:25]
    s_cbranch_scc1 L_B_d1poll
L_B_qget0:
    s_mov_b32 s51, 0
    buffer_load_dwordx4 v8, s[4:7], s33 offen offset:0 sc1 lds
    buffer_load_dwordx4 v9, s[4:7], s33 offen offset:1024 sc1 lds
    buffer_load_dwordx4 v10, s[4:7], s33 offen offset:2048 sc1 lds
    buffer_load_dwordx4 v11, s[4:7], s33 offen offset:3072 sc1 lds
L_B_qwait:
    s_waitcnt vmcnt(0) lgkmcnt(0)
L_B_qbar:
    s_add_u32 s57, s56, 32
    s_mul_i32 s57, s57, 9216
    s_lshl_b32 s50, s39, 8
    s_add_u32 s57, s57, s50
    s_mul_i32 s49, s47, 41472
    s_mul_i32 s50, s3, 9216
    s_add_u32 s49, s49, s50
    s_barrier
    ds_read_b128 v[64:67], v28 offset:0
    ds_read_b128 v[68:71], v29 offset:0
    ds_read_b128 v[72:75], v30 offset:0
    ds_read_b128 v[76:79], v31 offset:0
    ds_read_b128 v[80:83], v28 offset:256
    ds_read_b128 v[84:87], v29 offset:256
    ds_read_b128 v[88:91], v30 offset:256
    s_waitcnt lgkmcnt(6)
    v_mfma_f32_16x16x32_bf16 v[156:159], a[0:3], v[64:67], 0
    v_mfma_f32_16x16x32_bf16 v[160:163], a[64:67], v[64:67], 0
    ds_read_b128 v[92:95], v31 offset:256
    s_waitcnt lgkmcnt(6)
    v_mfma_f32_16x16x32_bf16 v[156:159], a[4:7], v[68:71], v[156:159]
    v_mfma_f32_16x16x32_bf16 v[160:163], a[68:71], v[68:71], v[160:163]
    ds_read_b128 v[96:99], v28 offset:512
    s_waitcnt lgkmcnt(6)
    v_mfma_f32_16x16x32_bf16 v[156:159], a[8:11], v[72:75], v[156:159]
    v_mfma_f32_16x16x32_bf16 v[160:163], a[72:75], v[72:75], v[160:163]
    buffer_load_dwordx4 v[200:203], v164, s[16:19], s57 offen nt
    s_add_u32 s57, s57, 36864
    ds_read_b128 v[100:103], v29 offset:512
    s_waitcnt lgkmcnt(6)
    v_mfma_f32_16x16x32_bf16 v[156:159], a[12:15], v[76:79], v[156:159]
    v_mfma_f32_16x16x32_bf16 v[160:163], a[76:79], v[76:79], v[160:163]
    buffer_load_dwordx4 v[204:207], v164, s[16:19], s57 offen nt
    s_add_u32 s57, s57, 36864
    s_cmp_ge_u32 s38, 4
    s_cselect_b32 s57, 5308416, s57
    ds_read_b128 v[104:107], v30 offset:512
    s_waitcnt lgkmcnt(6)
    v_mfma_f32_16x16x32_bf16 v[156:159], a[16:19], v[80:83], v[156:159]
    v_mfma_f32_16x16x32_bf16 v[160:163], a[80:83], v[80:83], v[160:163]
    buffer_load_dwordx4 v[208:211], v164, s[16:19], s57 offen nt
    ds_read_b128 v[108:111], v31 offset:512
    s_waitcnt lgkmcnt(6)
    v_mfma_f32_16x16x32_bf16 v[156:159], a[20:23], v[84:87], v[156:159]
    v_mfma_f32_16x16x32_bf16 v[160:163], a[84:87], v[84:87], v[160:163]
    s_add_u32 m0, s50, 23552
    s_nop 0
    buffer_load_dwordx4 v42, s[20:23], s49 offen nt lds
    ds_read_b128 v[112:115], v28 offset:768
    s_waitcnt lgkmcnt(6)
    v_mfma_f32_16x16x32_bf16 v[156:159], a[24:27], v[88:91], v[156:159]
    v_mfma_f32_16x16x32_bf16 v[160:163], a[88:91], v[88:91], v[160:163]
    s_add_u32 m0, s50, 24576
    s_nop 0
    buffer_load_dwordx4 v43, s[20:23], s49 offen nt lds
    ds_read_b128 v[116:119], v29 offset:768
    s_waitcnt lgkmcnt(6)
    v_mfma_f32_16x16x32_bf16 v[156:159], a[28:31], v[92:95], v[156:159]
    v_mfma_f32_16x16x32_bf16 v[160:163], a[92:95], v[92:95], v[160:163]
    s_add_u32 m0, s50, 25600
    s_nop 0
    buffer_load_dwordx4 v44, s[20:23], s49 offen nt lds
    ds_read_b128 v[120:123], v30 offset:768
    s_waitcnt lgkmcnt(6)
    v_mfma_f32_16x16x32_bf16 v[156:159], a[32:35], v[96:99], v[156:159]
    v_mfma_f32_16x16x32_bf16 v[160:163], a[96:99], v[96:99], v[160:163]
    s_add_u32 m0, s50, 26624
    s_nop 0
    buffer_load_dwordx4 v45, s[20:23], s49 offen nt lds
    ds_read_b128 v[124:127], v31 offset:768
    s_waitcnt lgkmcnt(6)
    v_mfma_f32_16x16x32_bf16 v[156:159], a[36:39], v[100:103], v[156:159]
    v_mfma_f32_16x16x32_bf16 v[160:163], a[100:103], v[100:103], v[160:163]
    s_waitcnt lgkmcnt(5)
    v_mfma_f32_16x16x32_bf16 v[156:159], a[40:43], v[104:107], v[156:159]
    v_mfma_f32_16x16x32_bf16 v[160:163], a[104:107], v[104:107], v[160:163]
    s_waitcnt lgkmcnt(4)
    v_mfma_f32_16x16x32_bf16 v[156:159], a[44:47], v[108:111], v[156:159]
    v_mfma_f32_16x16x32_bf16 v[160:163], a[108:111], v[108:111], v[160:163]
    s_waitcnt lgkmcnt(3)
    v_mfma_f32_16x16x32_bf16 v[156:159], a[48:51], v[112:115], v[156:159]
    v_mfma_f32_16x16x32_bf16 v[160:163], a[112:115], v[112:115], v[160:163]
    s_waitcnt lgkmcnt(2)
    v_mfma_f32_16x16x32_bf16 v[156:159], a[52:55], v[116:119], v[156:159]
    v_mfma_f32_16x16x32_bf16 v[160:163], a[116:119], v[116:119], v[160:163]
    s_waitcnt lgkmcnt(1)
    v_mfma_f32_16x16x32_bf16 v[156:159], a[56:59], v[120:123], v[156:159]
    v_mfma_f32_16x16x32_bf16 v[160:163], a[120:123], v[120:123], v[160:163]
    s_waitcnt lgkmcnt(0)
    v_mfma_f32_16x16x32_bf16 v[156:159], a[60:63], v[124:127], v[156:159]
    v_mfma_f32_16x16x32_bf16 v[160:163], a[124:127], v[124:127], v[160:163]
    s_mov_b32 s69, 0x3e0293ee
    s_nop 5
    v_cmp_u_f32 vcc, v156, v156
    v_max3_f32 v4, v156, v157, v158
    v_max3_f32 v5, v159, v160, v161
    v_max3_f32 v4, v4, v162, v163
    v_max_f32 v4, v4, v5
    s_cbranch_vccnz L_B_qslow
L_B_qok:
    ds_write_b32 v38, v4 offset:20480
    s_waitcnt lgkmcnt(0)
    s_barrier
    ds_read_b128 v[64:67], v39 offset:20480
    ds_read_b128 v[68:71], v39 offset:20736
    ds_read_b128 v[72:75], v39 offset:20992
    ds_read_b128 v[76:79], v39 offset:21248
    s_waitcnt lgkmcnt(2)
    v_max3_f32 v64, v64, v65, v66
    v_max3_f32 v67, v67, v68, v69
    v_max3_f32 v64, v64, v70, v71
    s_waitcnt lgkmcnt(0)
    v_max3_f32 v72, v72, v73, v74
    v_max3_f32 v75, v75, v76, v77
    v_max3_f32 v72, v72, v78, v79
    v_max3_f32 v64, v64, v67, v75
    v_max_f32 v64, v64, v72
    v_mul_f32 v34, s69, v64
    s_cmp_lg_u32 s3, 1
    s_cbranch_scc1 L_B_nostm
    s_mov_b64 exec, 0xffff
    buffer_store_dwordx4 v[34:37], v12, s[4:7], s59 offen sc1
    s_mov_b64 exec, -1
L_B_nostm:
    v_fma_f32 v156, v156, s69, -v34
    v_fma_f32 v157, v157, s69, -v34
    v_fma_f32 v158, v158, s69, -v34
    v_fma_f32 v159, v159, s69, -v34
    v_fma_f32 v160, v160, s69, -v34
    v_fma_f32 v161, v161, s69, -v34
    v_fma_f32 v162, v162, s69, -v34
    v_fma_f32 v163, v163, s69, -v34
    v_exp_f32 v156, v156
    v_exp_f32 v157, v157
    v_exp_f32 v158, v158
    v_exp_f32 v159, v159
    v_exp_f32 v160, v160
    v_exp_f32 v161, v161
    v_exp_f32 v162, v162
    v_exp_f32 v163, v163
    v_cvt_pk_bf16_f32 v80, v156, v157
    v_cvt_pk_bf16_f32 v81, v158, v159
    v_cvt_pk_bf16_f32 v82, v160, v161
    v_cvt_pk_bf16_f32 v83, v162, v163
    ds_write_b128 v41, v[80:83] offset:16384
    v_pk_add_f32 v[156:157], v[156:157], v[158:159]
    v_pk_add_f32 v[160:161], v[160:161], v[162:163]
    v_pk_add_f32 v[156:157], v[156:157], v[160:161]
    v_add_f32 v156, v156, v157
    ds_write_b32 v38, v156 offset:22528
    v_mfma_f32_16x16x32_bf16 v[96:99], v[80:83], a[128:131], 0
    v_mfma_f32_16x16x32_bf16 v[100:103], v[80:83], a[144:147], 0
    s_waitcnt lgkmcnt(0)
    s_barrier
    ds_read_b128 v[84:87], v20 offset:16384
    ds_read_b128 v[88:91], v21 offset:16384
    ds_read_b128 v[92:95], v23 offset:16384
    ds_read_b128 v[64:67], v39 offset:22528
    ds_read_b128 v[68:71], v39 offset:22784
    ds_read_b128 v[72:75], v39 offset:23040
    ds_read_b128 v[76:79], v39 offset:23296
    v_mfma_f32_16x16x32_bf16 v[104:107], v[80:83], a[160:163], 0
    v_mfma_f32_16x16x32_bf16 v[108:111], v[80:83], a[176:179], 0
    v_mfma_f32_16x16x32_bf16 v[112:115], v[80:83], a[192:195], 0
    v_mfma_f32_16x16x32_bf16 v[116:119], v[80:83], a[208:211], 0
    v_mfma_f32_16x16x32_bf16 v[120:123], v[80:83], a[224:227], 0
    v_mfma_f32_16x16x32_bf16 v[124:127], v[80:83], a[240:243], 0
    s_waitcnt lgkmcnt(6)
    v_mfma_f32_16x16x32_bf16 v[96:99], v[84:87], a[132:135], v[96:99]
    v_mfma_f32_16x16x32_bf16 v[100:103], v[84:87], a[148:151], v[100:103]
    v_mfma_f32_16x16x32_bf16 v[104:107], v[84:87], a[164:167], v[104:107]
    v_mfma_f32_16x16x32_bf16 v[108:111], v[84:87], a[180:183], v[108:111]
    s_waitcnt lgkmcnt(0)
    v_mfma_f32_16x16x32_bf16 v[112:115], v[84:87], a[196:199], v[112:115]
    v_pk_add_f32 v[64:65], v[64:65], v[66:67]
    v_pk_add_f32 v[68:69], v[68:69], v[70:71]
    v_mfma_f32_16x16x32_bf16 v[116:119], v[84:87], a[212:215], v[116:119]
    v_pk_add_f32 v[72:73], v[72:73], v[74:75]
    v_pk_add_f32 v[76:77], v[76:77], v[78:79]
    v_mfma_f32_16x16x32_bf16 v[120:123], v[84:87], a[228:231], v[120:123]
    v_pk_add_f32 v[64:65], v[64:65], v[68:69]
    v_pk_add_f32 v[72:73], v[72:73], v[76:77]
    v_mfma_f32_16x16x32_bf16 v[124:127], v[84:87], a[244:247], v[124:127]
    v_pk_add_f32 v[64:65], v[64:65], v[72:73]
    v_add_f32 v34, v64, v65
    s_cmp_lg_u32 s3, 0
    s_cbranch_scc1 L_B_nostl
    s_add_u32 s59, s59, 32768
    s_mov_b64 exec, 0xffff
    buffer_store_dwordx4 v[34:37], v12, s[4:7], s59 offen sc1
    s_mov_b64 exec, -1
L_B_nostl:
    v_mfma_f32_16x16x32_bf16 v[96:99], v[88:91], a[136:139], v[96:99]
    v_mfma_f32_16x16x32_bf16 v[100:103], v[88:91], a[152:155], v[100:103]
    v_mfma_f32_16x16x32_bf16 v[96:99], v[92:95], a[140:143], v[96:99]
    v_mfma_f32_16x16x32_bf16 v[100:103], v[92:95], a[156:159], v[100:103]
    v_mfma_f32_16x16x32_bf16 v[104:107], v[88:91], a[168:171], v[104:107]
    v_mfma_f32_16x16x32_bf16 v[108:111], v[88:91], a[184:187], v[108:111]
    v_mfma_f32_16x16x32_bf16 v[104:107], v[92:95], a[172:175], v[104:107]
    v_mfma_f32_16x16x32_bf16 v[108:111], v[92:95], a[188:191], v[108:111]
    v_mfma_f32_16x16x32_bf16 v[112:115], v[88:91], a[200:203], v[112:115]
    v_mfma_f32_16x16x32_bf16 v[116:119], v[88:91], a[216:219], v[116:119]
    s_nop 1
    v_cvt_pk_bf16_f32 v64, v96, v100
    v_cvt_pk_bf16_f32 v68, v97, v101
    v_mfma_f32_16x16x32_bf16 v[112:115], v[92:95], a[204:207], v[112:115]
    v_cvt_pk_bf16_f32 v72, v98, v102
    v_cvt_pk_bf16_f32 v76, v99, v103
    v_mfma_f32_16x16x32_bf16 v[116:119], v[92:95], a[220:223], v[116:119]
    v_and_or_b32 v64, v64, s36, v33
    v_and_or_b32 v68, v68, s36, v33
    v_and_or_b32 v72, v72, s36, v33
    v_and_or_b32 v76, v76, s36, v33
    v_mfma_f32_16x16x32_bf16 v[120:123], v[88:91], a[232:235], v[120:123]
    v_mfma_f32_16x16x32_bf16 v[124:127], v[88:91], a[248:251], v[124:127]
    v_cvt_pk_bf16_f32 v65, v104, v108
    v_cvt_pk_bf16_f32 v69, v105, v109
    v_mfma_f32_16x16x32_bf16 v[120:123], v[92:95], a[236:239], v[120:123]
    v_cvt_pk_bf16_f32 v73, v106, v110
    v_cvt_pk_bf16_f32 v77, v107, v111
    v_mfma_f32_16x16x32_bf16 v[124:127], v[92:95], a[252:255], v[124:127]
    v_and_or_b32 v65, v65, s36, v33
    v_and_or_b32 v69, v69, s36, v33
    v_and_or_b32 v73, v73, s36, v33
    v_and_or_b32 v77, v77, s36, v33
    v_cvt_pk_bf16_f32 v66, v112, v116
    v_cvt_pk_bf16_f32 v70, v113, v117
    v_cvt_pk_bf16_f32 v74, v114, v118
    v_cvt_pk_bf16_f32 v78, v115, v119
    v_and_or_b32 v66, v66, s36, v33
    v_and_or_b32 v70, v70, s36, v33
    v_and_or_b32 v74, v74, s36, v33
    v_and_or_b32 v78, v78, s36, v33
    v_cvt_pk_bf16_f32 v67, v120, v124
    v_and_or_b32 v67, v67, s36, v33
    s_add_u32 s48, s61, 0
    buffer_store_dwordx4 v[64:67], v13, s[4:7], s48 offen sc1
    v_cvt_pk_bf16_f32 v71, v121, v125
    v_and_or_b32 v71, v71, s36, v33
    s_add_u32 s48, s61, 66560
    buffer_store_dwordx4 v[68:71], v13, s[4:7], s48 offen sc1
    v_cvt_pk_bf16_f32 v75, v122, v126
    v_and_or_b32 v75, v75, s36, v33
    s_add_u32 s48, s61, 133120
    buffer_store_dwordx4 v[72:75], v13, s[4:7], s48 offen sc1
    v_cvt_pk_bf16_f32 v79, v123, v127
    v_and_or_b32 v79, v79, s36, v33
    s_add_u32 s48, s61, 199680
    buffer_store_dwordx4 v[76:79], v13, s[4:7], s48 offen sc1
    s_waitcnt vmcnt(8)
    v_mfma_f32_16x16x32_bf16 v[140:143], v[212:215], v[168:171], 0
    v_mfma_f32_16x16x32_bf16 v[140:143], v[216:219], v[172:175], v[140:143]
    v_mfma_f32_16x16x32_bf16 v[140:143], v[220:223], v[176:179], v[140:143]
    v_mfma_f32_16x16x32_bf16 v[140:143], v[224:227], v[180:183], v[140:143]
    v_mfma_f32_16x16x32_bf16 v[140:143], v[228:231], v[184:187], v[140:143]
    v_mfma_f32_16x16x32_bf16 v[140:143], v[232:235], v[188:191], v[140:143]
    v_mfma_f32_16x16x32_bf16 v[140:143], v[236:239], v[192:195], v[140:143]
    v_mfma_f32_16x16x32_bf16 v[140:143], v[240:243], v[196:199], v[140:143]
    v_mfma_f32_16x16x32_bf16 v[140:143], v[244:247], v[200:203], v[140:143]
    v_mfma_f32_16x16x32_bf16 v[140:143], v[248:251], v[204:207], v[140:143]
    s_cmp_ge_u32 s38, 4
    s_cbranch_scc1 L_B_w1s
    v_mfma_f32_16x16x32_bf16 v[140:143], v[252:255], v[208:211], v[140:143]
L_B_w1s:
    s_mul_i32 s48, s38, 36864
    s_lshl_b32 s50, s39, 9
    s_add_u32 s48, s48, s50
    s_add_u32 s48, s48, 3407872
    s_and_b32 s50, s40, 15
    s_nop 2
    v_and_or_b32 v140, v140, -16, s50
    v_and_or_b32 v141, v141, -16, s50
    v_and_or_b32 v142, v142, -16, s50
    v_and_or_b32 v143, v143, -16, s50
    s_mov_b32 s56, s48
    buffer_store_dwordx4 v[140:143], v165, s[4:7], s56 offen sc1
    s_mul_i32 s69, s47, 41472
    s_mul_i32 s48, s3, 9216
    s_add_u32 s48, s48, s69
    s_mul_i32 s64, s3, 9216
    s_add_u32 m0, s64, 27648
    s_nop 0
    buffer_load_dwordx4 v46, s[20:23], s48 offen nt lds
    s_add_u32 m0, s64, 28672
    s_nop 0
    buffer_load_dwordx4 v47, s[20:23], s48 offen nt lds
    s_add_u32 m0, s64, 29696
    s_nop 0
    buffer_load_dwordx4 v48, s[20:23], s48 offen nt lds
    s_add_u32 m0, s64, 30720
    s_nop 0
    buffer_load_dwordx4 v49, s[20:23], s48 offen nt lds
    s_add_u32 m0, s64, 31744
    s_nop 0
    buffer_load_dwordx4 v50, s[20:23], s48 offen nt lds
    s_add_u32 s48, s69, 36864
    s_lshl_b32 s64, s3, 10
    s_add_u32 m0, s64, 60416
    s_nop 0
    buffer_load_dwordx4 v51, s[20:23], s48 offen nt lds
    s_mov_b32 exec_hi, 0
    s_mov_b32 m0, 64512
    s_nop 0
    buffer_load_dwordx4 v46, s[20:23], s48 offen nt lds
    s_mov_b64 exec, -1
    s_waitcnt vmcnt(4)
    s_and_b32 s64, s3, 1
    s_mul_i32 s48, s64, 18432
    s_add_u32 s48, s48, 3407872
    s_add_u32 s49, s48, 147456
    s_add_u32 s50, s48, 294912
    s_add_u32 s69, s48, 442368
    s_and_b32 s32, s40, 15
    s_mov_b32 s51, 0
    v_mov_b32 v92, s32
    v_mov_b32 v93, s32
    v_mov_b32 v94, s32
    v_mov_b32 v95, s32
    s_cmp_gt_u32 s3, 1
    s_cbranch_scc1 L_B_noh1
    s_mov_b32 exec_lo, 0x01ff01ff
    s_mov_b32 exec_hi, 0x01ff01ff
    buffer_load_dwordx4 v[80:83], v56, s[4:7], s48 offen sc1
    buffer_load_dwordx4 v[84:87], v56, s[4:7], s49 offen sc1
    buffer_load_dwordx4 v[88:91], v56, s[4:7], s50 offen sc1
    s_mov_b32 exec_hi, 0
    buffer_load_dwordx4 v[92:95], v56, s[4:7], s69 offen sc1
    s_mov_b64 exec, -1
L_B_noh1:
    s_cmp_gt_u32 s3, 1
    s_cbranch_scc1 L_B_hbar
    s_waitcnt vmcnt(0)
L_B_hchk:
    s_mov_b32 exec_lo, 0x01ff01ff
    s_mov_b32 exec_hi, 0x01ff01ff
    v_xor_b32 v100, s32, v80
    v_xor_b32 v101, s32, v81
    v_xor_b32 v102, s32, v82
    v_xor_b32 v103, s32, v83
    v_xor_b32 v104, s32, v84
    v_xor_b32 v105, s32, v85
    v_xor_b32 v106, s32, v86
    v_xor_b32 v107, s32, v87
    v_xor_b32 v108, s32, v88
    v_xor_b32 v109, s32, v89
    v_xor_b32 v110, s32, v90
    v_xor_b32 v111, s32, v91
    v_xor_b32 v112, s32, v92
    v_xor_b32 v113, s32, v93
    v_xor_b32 v114, s32, v94
    v_xor_b32 v115, s32, v95
    v_or3_b32 v96, v100, v101, v102
    v_or3_b32 v96, v96, v103, v104
    v_or3_b32 v96, v96, v105, v106
    v_or3_b32 v96, v96, v107, v108
    v_or3_b32 v96, v96, v109, v110
    v_or3_b32 v96, v96, v111, v112
    v_or3_b32 v96, v96, v113, v114
    v_or_b32 v96, v96, v115
    v_and_b32 v96, 15, v96
    v_cmp_ne_u32 vcc, 0, v96
    s_cbranch_vccnz L_B_hslow
L_B_hok:
    v_pk_add_f32 v[100:101], v[100:101], v[104:105]
    v_pk_add_f32 v[102:103], v[102:103], v[106:107]
    v_pk_add_f32 v[108:109], v[108:109], v[112:113]
    v_pk_add_f32 v[110:111], v[110:111], v[114:115]
    v_pk_add_f32 v[100:101], v[100:101], v[108:109]
    v_pk_add_f32 v[102:103], v[102:103], v[110:111]
    v_lshlrev_b32 v22, 16, v22
    v_mov_b32 v5, 0xc0135761
    v_permlane32_swap_b32 v100, v101
    v_permlane32_swap_b32 v102, v103
    v_add_f32 v100, v100, v101
    v_add_f32 v102, v102, v103
    s_mov_b32 s69, 0xbdd2d3e8
    s_nop 0
    v_permlane16_swap_b32 v100, v102
    v_add_f32 v100, v100, v102
    v_add_f32 v100, v100, v22
    v_mul_f32 v4, v100, v100
    v_fma_f32 v4, v4, s69, v5
    v_mul_f32 v4, v4, v100
    v_exp_f32 v4, v4
    s_nop 0
    v_add_f32 v4, 1.0, v4
    v_rcp_f32 v4, v4
    s_nop 0
    v_mul_f32 v4, v4, v100
    v_cvt_pk_bf16_f32 v4, v4, v4
    ds_write_b16 v57, v4 offset:21504
    s_mov_b64 exec, -1
L_B_hbar:
    s_waitcnt vmcnt(0) lgkmcnt(0)
    s_barrier
    ds_read2_b64 v[64:67], v58 offset0:0 offset1:4
    ds_read2_b64 v[70:73], v59 offset0:0 offset1:4
    ds_read_b64_tr_b16 a[0:1], v52 offset:0
    ds_read_b64_tr_b16 a[2:3], v52 offset:18432
    ds_read_b64_tr_b16 a[6:7], v53 offset:0
    ds_read_b64_tr_b16 a[8:9], v53 offset:18432
    ds_read_b64_tr_b16 a[12:13], v52 offset:256
    ds_read_b64_tr_b16 a[14:15], v52 offset:18688
    ds_read_b64_tr_b16 a[18:19], v53 offset:256
    ds_read_b64_tr_b16 a[20:21], v53 offset:18688
    ds_read_b64_tr_b16 a[24:25], v52 offset:512
    ds_read_b64_tr_b16 a[26:27], v52 offset:18944
    ds_read_b64_tr_b16 a[30:31], v53 offset:512
    ds_read_b64_tr_b16 a[32:33], v53 offset:18944
    s_waitcnt lgkmcnt(8)
    v_mfma_f32_16x16x32_bf16 v[96:99], v[64:67], a[0:3], 0
    v_mfma_f32_16x16x32_bf16 v[96:99], v[70:73], a[6:9], v[96:99]
    ds_read_b64_tr_b16 a[36:37], v52 offset:768
    ds_read_b64_tr_b16 a[38:39], v52 offset:19200
    ds_read_b64_tr_b16 a[42:43], v53 offset:768
    ds_read_b64_tr_b16 a[44:45], v53 offset:19200
    s_waitcnt lgkmcnt(8)
    v_mfma_f32_16x16x32_bf16 v[100:103], v[64:67], a[12:15], 0
    v_mfma_f32_16x16x32_bf16 v[100:103], v[70:73], a[18:21], v[100:103]
    ds_read_b64_tr_b16 a[48:49], v52 offset:1024
    ds_read_b64_tr_b16 a[50:51], v52 offset:19456
    ds_read_b64_tr_b16 a[54:55], v53 offset:1024
    ds_read_b64_tr_b16 a[56:57], v53 offset:19456
    s_waitcnt lgkmcnt(8)
    v_mfma_f32_16x16x32_bf16 v[104:107], v[64:67], a[24:27], 0
    v_mfma_f32_16x16x32_bf16 v[104:107], v[70:73], a[30:33], v[104:107]
    ds_read_b64 v[68:69], v60
    ds_read_b64 v[74:75], v61
    ds_read_b64_tr_b16 a[4:5], v54 offset:0
    ds_read_b64_tr_b16 a[10:11], v55 offset:0
    ds_read_b64_tr_b16 a[16:17], v54 offset:256
    ds_read_b64_tr_b16 a[22:23], v55 offset:256
    s_waitcnt lgkmcnt(10)
    v_mfma_f32_16x16x32_bf16 v[108:111], v[64:67], a[36:39], 0
    v_mfma_f32_16x16x32_bf16 v[108:111], v[70:73], a[42:45], v[108:111]
    ds_read_b64_tr_b16 a[28:29], v54 offset:512
    ds_read_b64_tr_b16 a[34:35], v55 offset:512
    ds_read_b64_tr_b16 a[40:41], v54 offset:768
    ds_read_b64_tr_b16 a[46:47], v55 offset:768
    ds_read_b64_tr_b16 a[52:53], v54 offset:1024
    ds_read_b64_tr_b16 a[58:59], v55 offset:1024
    s_waitcnt lgkmcnt(12)
    v_mfma_f32_16x16x32_bf16 v[112:115], v[64:67], a[48:51], 0
    v_mfma_f32_16x16x32_bf16 v[112:115], v[70:73], a[54:57], v[112:115]
    s_waitcnt lgkmcnt(8)
    v_mfma_f32_16x16x16_bf16 v[96:99], v[68:69], a[4:5], v[96:99]
    v_mfma_f32_16x16x16_bf16 v[96:99], v[74:75], a[10:11], v[96:99]
    s_waitcnt lgkmcnt(6)
    v_mfma_f32_16x16x16_bf16 v[100:103], v[68:69], a[16:17], v[100:103]
    v_mfma_f32_16x16x16_bf16 v[100:103], v[74:75], a[22:23], v[100:103]
    s_waitcnt lgkmcnt(4)
    v_mfma_f32_16x16x16_bf16 v[104:107], v[68:69], a[28:29], v[104:107]
    v_mfma_f32_16x16x16_bf16 v[104:107], v[74:75], a[34:35], v[104:107]
    s_waitcnt lgkmcnt(2)
    v_mfma_f32_16x16x16_bf16 v[108:111], v[68:69], a[40:41], v[108:111]
    v_mfma_f32_16x16x16_bf16 v[108:111], v[74:75], a[46:47], v[108:111]
    s_waitcnt lgkmcnt(0)
    v_mfma_f32_16x16x16_bf16 v[112:115], v[68:69], a[52:53], v[112:115]
    v_mfma_f32_16x16x16_bf16 v[112:115], v[74:75], a[58:59], v[112:115]
    v_and_or_b32 v64, v96, -16, s32
    v_and_or_b32 v65, v100, -16, s32
    v_and_or_b32 v66, v104, -16, s32
    s_nop 1
    v_and_or_b32 v67, v108, -16, s32
    buffer_store_dwordx4 v[64:67], v14, s[4:7], s62 offen sc1
    s_cmp_gt_u32 s3, 1
    s_cbranch_scc1 L_B_no5b
    v_and_or_b32 v112, v112, -16, s32
    buffer_store_dword v112, v15, s[4:7], s63 offen sc1
L_B_no5b:
    s_endpgm
L_B_hslow:
    s_add_u32 s51, s51, 1
    s_cmp_gt_u32 s51, 1048576
    s_cbranch_scc1 L_B_hok
    s_mov_b32 exec_lo, 0x01ff01ff
    s_mov_b32 exec_hi, 0x01ff01ff
    buffer_load_dwordx4 v[80:83], v56, s[4:7], s48 offen sc1
    buffer_load_dwordx4 v[84:87], v56, s[4:7], s49 offen sc1
    buffer_load_dwordx4 v[88:91], v56, s[4:7], s50 offen sc1
    s_mov_b32 exec_hi, 0
    buffer_load_dwordx4 v[92:95], v56, s[4:7], s69 offen sc1
    s_mov_b64 exec, -1
    s_waitcnt vmcnt(0)
    s_branch L_B_hchk
L_B_qslow:
    s_add_u32 s51, s51, 1
    s_cmp_gt_u32 s51, 1048576
    s_cbranch_scc1 L_B_qok
    s_mov_b64 s[52:53], 0
    v_cmp_eq_u32 vcc, s68, v64
    s_nop 0
    s_or_b64 s[52:53], s[52:53], vcc
    v_cmp_eq_u32 vcc, s68, v68
    s_nop 0
    s_or_b64 s[52:53], s[52:53], vcc
    v_cmp_eq_u32 vcc, s68, v72
    s_nop 0
    s_or_b64 s[52:53], s[52:53], vcc
    v_cmp_eq_u32 vcc, s68, v76
    s_nop 0
    s_or_b64 s[52:53], s[52:53], vcc
    v_cmp_eq_u32 vcc, s68, v80
    s_nop 0
    s_or_b64 s[52:53], s[52:53], vcc
    v_cmp_eq_u32 vcc, s68, v84
    s_nop 0
    s_or_b64 s[52:53], s[52:53], vcc
    v_cmp_eq_u32 vcc, s68, v88
    s_nop 0
    s_or_b64 s[52:53], s[52:53], vcc
    v_cmp_eq_u32 vcc, s68, v92
    s_nop 0
    s_or_b64 s[52:53], s[52:53], vcc
    v_cmp_eq_u32 vcc, s68, v96
    s_nop 0
    s_or_b64 s[52:53], s[52:53], vcc
    v_cmp_eq_u32 vcc, s68, v100
    s_nop 0
    s_or_b64 s[52:53], s[52:53], vcc
    v_cmp_eq_u32 vcc, s68, v104
    s_nop 0
    s_or_b64 s[52:53], s[52:53], vcc
    v_cmp_eq_u32 vcc, s68, v108
    s_nop 0
    s_or_b64 s[52:53], s[52:53], vcc
    v_cmp_eq_u32 vcc, s68, v112
    s_nop 0
    s_or_b64 s[52:53], s[52:53], vcc
    v_cmp_eq_u32 vcc, s68, v116
    s_nop 0
    s_or_b64 s[52:53], s[52:53], vcc
    v_cmp_eq_u32 vcc, s68, v120
    s_nop 0
    s_or_b64 s[52:53], s[52:53], vcc
    v_cmp_eq_u32 vcc, s68, v124
    s_nop 0
    s_or_b64 s[52:53], s[52:53], vcc
    s_cbranch_scc0 L_B_qok
    s_barrier
    s_lshl_b32 m0, s3, 12
    s_nop 0
    buffer_load_dwordx4 v8, s[4:7], s33 offen offset:0 sc1 lds
    buffer_load_dwordx4 v9, s[4:7], s33 offen offset:1024 sc1 lds
    buffer_load_dwordx4 v10, s[4:7], s33 offen offset:2048 sc1 lds
    buffer_load_dwordx4 v11, s[4:7], s33 offen offset:3072 sc1 lds
    s_waitcnt vmcnt(0)
    s_branch L_B_qbar
L_end:
    s_endpgm
L_code_end:
.fill (20480 + 256 - (L_code_end - gated_mix__compressed_kv_cla__dense_activation_gelu__decode_kernel)) / 4, 4, 0xbf800000
.section .rodata,"a"
.p2align 6
.amdhsa_kernel gated_mix__compressed_kv_cla__dense_activation_gelu__decode_kernel
  .amdhsa_next_free_vgpr 512
  .amdhsa_next_free_sgpr 102
  .amdhsa_accum_offset 256
  .amdhsa_group_segment_fixed_size 0
  .amdhsa_kernarg_size 120
  .amdhsa_user_sgpr_count 2
  .amdhsa_user_sgpr_kernarg_segment_ptr 1
  .amdhsa_system_sgpr_workgroup_id_x 1
.end_amdhsa_kernel
```
